```python
import torch

def _softmax(x, axis=-1):
    return torch.softmax(x, dim=axis)
def _gelu(x):
    return torch.nn.functional.gelu(x, approximate="tanh")
def _silu(x):
    return torch.nn.functional.silu(x)
def _sigmoid(x):
    return torch.sigmoid(x)
def _layernorm(x, axis=-1, eps=1e-5):
    m = x.mean(dim=axis, keepdim=True)
    v = x.var(dim=axis, keepdim=True, unbiased=False)
    return (x - m) / torch.sqrt(v + eps)
def _scatter_add(tgt, idx, src, axis=0):
    return tgt.clone().index_add_(axis, idx, src)
def _segment_sum(src, seg, n):
    out = torch.zeros((n,) + src.shape[1:], dtype=src.dtype)
    return out.index_add_(0, seg, src)
def _pad(x, pw):
    flat = tuple(v for pair in reversed(pw) for v in pair)
    return torch.nn.functional.pad(x, flat)

kernel_name = 'sequential_preLN__sliding_block_cached__dense_activation_gelu__decode'

def setup_inputs():

    _w = (lambda a: (lambda t: t.to(torch.bfloat16) if t.is_floating_point() else t)(torch.as_tensor(a)))
    def _A_setup():
        B, Sq, D = 8, 1, 512
        Hq, Hkv, Sk, Dh = 32, 8, 4096, 128
        assert Hq % Hkv == 0, (Hq, Hkv)
        return {
            "x": _w((lambda *s: torch.randn(*s, dtype=torch.bfloat16) * 0.05)(B, Sq, D)),
            "k_cache": _w((lambda *s: torch.randn(*s, dtype=torch.bfloat16) * 1.6)(B, Hkv, Sk, Dh)),
            "v_cache": _w((lambda *s: torch.randn(*s, dtype=torch.bfloat16) * 0.4)(B, Hkv, Sk, Dh)),
            "wq": _w((lambda *s: torch.randn(*s, dtype=torch.bfloat16) * 1.6)(D, Hq * Dh) * (D ** -0.5)),
            "wo": _w((lambda *s: torch.randn(*s, dtype=torch.bfloat16) * 0.4)(Hq * Dh, D) * ((Hq * Dh) ** -0.5)),
        }
    _A_in = _A_setup()

    def _B_setup():
        B, S, D, F = 8, 1, 512, 1792
        return {
            "x": _w((lambda *s: torch.randn(*s, dtype=torch.bfloat16) * 0.05)(B, S, D)),
            "w1": _w((lambda *s: torch.randn(*s, dtype=torch.bfloat16) * 0.8)(D, F) * (D ** -0.5)),
            "b1": _w((lambda *s: torch.randn(*s, dtype=torch.bfloat16) * 0.8)(F) * 0.01),
            "w2": _w((lambda *s: torch.randn(*s, dtype=torch.bfloat16) * 0.1)(F, D) * (F ** -0.5)),
            "b2": _w((lambda *s: torch.randn(*s, dtype=torch.bfloat16) * 0.1)(D) * 0.01),
        }
    _B_in = _B_setup()

    return {
        "A_x": _A_in["x"],
        "A_k_cache": _A_in["k_cache"],
        "A_v_cache": _A_in["v_cache"],
        "A_wq": _A_in["wq"],
        "A_wo": _A_in["wo"],
        "B_x": _B_in["x"],
        "B_w1": _B_in["w1"],
        "B_b1": _B_in["b1"],
        "B_w2": _B_in["w2"],
        "B_b2": _B_in["b2"],
    }

def reference(A_x, A_k_cache, A_v_cache, A_wq, A_wo, B_x, B_w1, B_b1, B_w2, B_b2):
    def _A_ref(x, k_cache, v_cache, wq, wo):
        B, Sq, D = x.shape
        Hq, Dh = 32, 128
        Hkv, Sk = k_cache.shape[1], k_cache.shape[2]
        W = min(4096, max(256, Sk // 4))
        rep = Hq // Hkv
        q = (lambda x, *d: x.permute(*d))((x @ wq).reshape(B, Sq, Hq, Dh), 0, 2, 1, 3)
        k = (lambda x, n, axis: torch.repeat_interleave(x, n, dim=axis))(k_cache[:, :, Sk - W:, :], rep, axis=1)
        v = (lambda x, n, axis: torch.repeat_interleave(x, n, dim=axis))(v_cache[:, :, Sk - W:, :], rep, axis=1)
        scores = torch.einsum("bhqd,bhkd->bhqk", q, k) * (Dh ** -0.5)
        p = _softmax(scores, axis=-1)
        o = torch.einsum("bhqk,bhkd->bhqd", p, v)
        return (lambda x, *d: x.permute(*d))(o, 0, 2, 1, 3).reshape(B, Sq, Hq * Dh) @ wo

    def _B_ref(x, w1, b1, w2, b2):
        h = torch.einsum("bsd,df->bsf", x, w1) + b1
        h = _gelu(h)
        return torch.einsum("bsf,fd->bsd", h, w2) + b2

    x = A_x
    h = x + _A_ref(_layernorm(x, axis=-1), A_k_cache, A_v_cache, A_wq, A_wo)
    h2 = h + _B_ref(_layernorm(h, axis=-1), B_w1, B_b1, B_w2, B_b2)
    return h2
```

```asm
; @launch grid=(256,1,1) block=(384,1,1) lds=147200
.amdgcn_target "amdgcn-amd-amdhsa--gfx950"
.text
.globl sequential_preLN__sliding_block_cached__dense_activation_gelu__decode_kernel
.p2align 8
.type sequential_preLN__sliding_block_cached__dense_activation_gelu__decode_kernel,@function
sequential_preLN__sliding_block_cached__dense_activation_gelu__decode_kernel:
    s_load_dwordx2 s[68:69], s[0:1], 0
    s_load_dwordx2 s[72:73], s[0:1], 24
    s_load_dwordx2 s[52:53], s[0:1], 96
    s_load_dwordx2 s[44:45], s[0:1], 8
    s_load_dwordx2 s[48:49], s[0:1], 16
    v_readfirstlane_b32 s3, v0
    s_getpc_b64 s[88:89]
L_pc:
    v_lshlrev_b32 v1, 7, v0
    v_min_u32 v1, L_codeend-L_pc-4, v1
    global_load_dword v18, v1, s[88:89]
    s_cmp_ge_u32 s2, 256
    s_cbranch_scc1 L_end
    s_and_b32 s30, s2, 7
    s_lshr_b32 s31, s2, 3
    s_lshr_b32 s3, s3, 6
    s_cbranch_scc1 L_main
    s_setprio 2
    v_lshrrev_b32 v1, 4, v0
    v_bfe_u32 v8, v0, 3, 1
    v_and_b32 v10, 7, v0
    v_lshlrev_b32 v6, 6, v8
    v_lshl_add_u32 v6, v1, 4, v6
    v_lshl_add_u32 v5, v10, 10, v6
    s_movk_i32 s70, 0x2000
    s_mov_b32 s71, 0x00020000
    s_lshr_b32 s90, s31, 3
    s_lshl_b32 s88, s90, 20
    s_lshl_b32 s90, s90, 8
    v_lshl_add_u32 v9, v8, 2, v1
    v_lshlrev_b32 v9, 16, v9
    v_lshl_add_u32 v4, v10, 4, v9
    s_lshl_b32 s89, s30, 3
    s_and_b32 s4, s31, 7
    s_add_u32 s89, s89, s4
    s_lshl_b32 s89, s89, 7
    s_add_u32 s88, s88, s89
    s_mov_b32 s74, 4194304
    s_mov_b32 s75, 0x00020000
    v_and_b32 v11, 31, v0
    v_mov_b32 v12, 145536
    v_lshl_add_u32 v11, v11, 2, v12
    v_mov_b32 v13, 0
    ds_write_b32 v11, v13
    s_waitcnt lgkmcnt(0)
    buffer_load_dwordx4 v[32:35], v5, s[68:71], 0 offen offset:0
    buffer_load_dwordx4 v[36:39], v5, s[68:71], 0 offen offset:128
    buffer_load_dwordx4 v[40:43], v5, s[68:71], 0 offen offset:256
    buffer_load_dwordx4 v[44:47], v5, s[68:71], 0 offen offset:384
    buffer_load_dwordx4 v[48:51], v5, s[68:71], 0 offen offset:512
    buffer_load_dwordx4 v[52:55], v5, s[68:71], 0 offen offset:640
    buffer_load_dwordx4 v[56:59], v5, s[68:71], 0 offen offset:768
    buffer_load_dwordx4 v[60:63], v5, s[68:71], 0 offen offset:896
    buffer_load_dwordx4 v[24:27], v5, s[68:71], s90 offen offset:0
    buffer_load_dwordx4 v[28:31], v5, s[68:71], s90 offen offset:128
    buffer_load_dwordx4 v[64:67], v4, s[72:75], s88 offen nt
    s_addk_i32 s88, 0x2000
    buffer_load_dwordx4 v[68:71], v4, s[72:75], s88 offen nt
    s_addk_i32 s88, 0x2000
    buffer_load_dwordx4 v[72:75], v4, s[72:75], s88 offen nt
    s_addk_i32 s88, 0x2000
    buffer_load_dwordx4 v[76:79], v4, s[72:75], s88 offen nt
    s_addk_i32 s88, 0x2000
    buffer_load_dwordx4 v[80:83], v4, s[72:75], s88 offen nt
    s_addk_i32 s88, 0x2000
    buffer_load_dwordx4 v[84:87], v4, s[72:75], s88 offen nt
    s_addk_i32 s88, 0x2000
    buffer_load_dwordx4 v[88:91], v4, s[72:75], s88 offen nt
    s_addk_i32 s88, 0x2000
    buffer_load_dwordx4 v[92:95], v4, s[72:75], s88 offen nt
    s_add_u32 s88, s88, 466944
    buffer_load_dwordx4 v[96:99], v4, s[72:75], s88 offen nt
    s_addk_i32 s88, 0x2000
    buffer_load_dwordx4 v[100:103], v4, s[72:75], s88 offen nt
    s_addk_i32 s88, 0x2000
    buffer_load_dwordx4 v[104:107], v4, s[72:75], s88 offen nt
    s_addk_i32 s88, 0x2000
    buffer_load_dwordx4 v[108:111], v4, s[72:75], s88 offen nt
    s_addk_i32 s88, 0x2000
    buffer_load_dwordx4 v[112:115], v4, s[72:75], s88 offen nt
    s_addk_i32 s88, 0x2000
    buffer_load_dwordx4 v[116:119], v4, s[72:75], s88 offen nt
    s_addk_i32 s88, 0x2000
    buffer_load_dwordx4 v[120:123], v4, s[72:75], s88 offen nt
    s_addk_i32 s88, 0x2000
    buffer_load_dwordx4 v[124:127], v4, s[72:75], s88 offen nt
    s_load_dwordx2 s[38:39], s[52:53], 0
    s_mov_b32 s54, 268435456
    s_mov_b32 s55, 0x00020000
    v_and_b32 v2, 15, v0
    v_lshlrev_b32 v3, 4, v0
    v_lshl_add_u32 v6, v10, 13, v6
    v_mov_b32 v20, -1
    v_mov_b32 v21, -1
    v_mov_b32 v22, -1
    v_mov_b32 v23, -1
    s_lshl_b32 s4, s30, 5
    s_add_u32 s4, s4, s31
    s_lshl_b32 s5, s30, 15
    s_lshl_b32 s6, s31, 6
    s_add_u32 s5, s5, s6
    s_add_u32 s5, s5, 1572864
    v_lshrrev_b32 v17, 2, v0
    v_lshlrev_b32 v17, 11, v17
    v_and_b32 v9, 3, v0
    v_lshl_add_u32 v17, v9, 4, v17
    s_lshl_b32 s6, s30, 9
    s_lshl_b32 s7, s31, 2
    s_add_u32 s6, s6, s7
    s_add_u32 s6, s6, 8192
    v_lshlrev_b32 v7, 7, v0
    v_lshrrev_b32 v16, 3, v0
    v_lshlrev_b32 v16, 11, v16
    v_lshl_add_u32 v16, v10, 4, v16
    v_lshrrev_b32 v9, 5, v0
    v_lshl_add_u32 v16, v9, 30, v16
    s_lshl_b32 s7, s30, 13
    s_lshl_b32 s8, s31, 7
    s_add_u32 s7, s7, s8
    s_add_u32 s7, s7, 65536
    s_cmp_lt_u32 s31, 16
    s_cbranch_scc1 L_hc
    v_mov_b32 v16, v3
    s_mul_i32 s7, s30, 7
    s_lshr_b32 s8, s31, 1
    s_add_u32 s7, s7, s8
    s_lshl_b32 s7, s7, 10
    s_add_u32 s7, s7, 122880
    s_and_b32 s8, s31, 1
    s_cselect_b32 s7, 0x40000000, s7
    s_cmp_ge_u32 s31, 30
    s_cselect_b32 s7, 0x40000000, s7
L_hc:
    s_cmp_ge_u32 s30, 4
    s_cselect_b32 s7, 0x40000000, s7
    s_mov_b32 s8, s5
    s_mov_b32 s9, s6
    s_mov_b32 s10, s7
    buffer_store_dwordx4 v[20:23], v17, s[52:55], s5 offen
    s_mov_b64 exec, 15
    buffer_store_dword v20, v7, s[52:55], s6 offen
    s_mov_b64 exec, -1
    buffer_store_dwordx4 v[20:23], v16, s[52:55], s7 offen
    s_barrier
    s_branch L_qrest
L_main:
    v_and_b32 v0, 63, v0
    v_lshrrev_b32 v1, 4, v0
    v_and_b32 v2, 15, v0
    v_lshlrev_b32 v3, 4, v0
    s_mov_b32 s54, 268435456
    s_mov_b32 s55, 0x00020000
    s_cmp_lg_u32 s3, 5
    s_cbranch_scc1 L_main2
    s_barrier
    s_branch L_probe
L_main2:
    s_sub_u32 s34, s3, 1
    s_setprio 1
    s_mov_b32 s46, 67108864
    s_mov_b32 s47, 0x00020000
    s_mov_b32 s50, 67108864
    s_mov_b32 s51, 0x00020000
    v_lshlrev_b32 v8, 2, v1
    v_xor_b32 v8, v8, v2
    v_lshlrev_b32 v9, 12, v1
    v_lshl_add_u32 v247, v2, 4, v9
    v_xor_b32 v4, 0, v8
    v_lshl_add_u32 v4, v4, 4, v9
    v_xor_b32 v5, 1, v8
    v_lshl_add_u32 v5, v5, 4, v9
    v_xor_b32 v6, 2, v8
    v_lshl_add_u32 v6, v6, 4, v9
    v_xor_b32 v7, 3, v8
    v_lshl_add_u32 v7, v7, 4, v9
    s_lshr_b32 s89, s31, 2
    s_lshl_b32 s95, s89, 3
    s_add_u32 s95, s95, s30
    s_lshl_b32 s95, s95, 20
    s_and_b32 s88, s31, 3
    s_lshl_b32 s88, s88, 10
    s_lshl_b32 s5, s34, 8
    s_add_u32 s88, s88, s5
    s_add_u32 s95, s95, s88
    s_add_u32 s95, s95, 786432
    s_lshl_b32 m0, s34, 14
    s_add_u32 s88, s34, s89
    s_lshl_b32 s88, s88, 12
    s_and_b32 s84, s88, 0
    s_add_u32 s84, s84, s95
    s_add_u32 s88, s88, 4096
    s_and_b32 s85, s88, 0
    s_add_u32 s85, s85, s95
    s_add_u32 s85, s85, 16384
    s_add_u32 s88, s88, 4096
    s_and_b32 s86, s88, 0
    s_add_u32 s86, s86, s95
    s_add_u32 s86, s86, 32768
    s_add_u32 s88, s88, 4096
    s_and_b32 s87, s88, 0
    s_add_u32 s87, s87, s95
    s_add_u32 s87, s87, 49152
    s_nop 0
    s_waitcnt lgkmcnt(0)
    s_barrier
    buffer_load_dwordx4 v4, s[44:47], s84 offen nt lds
    s_add_u32 m0, m0, 1024
    s_add_u32 s84, s84, 65536
    buffer_load_dwordx4 v5, s[44:47], s85 offen nt lds
    s_add_u32 m0, m0, 1024
    s_add_u32 s85, s85, 65536
    buffer_load_dwordx4 v6, s[44:47], s86 offen nt lds
    s_add_u32 m0, m0, 1024
    s_add_u32 s86, s86, 65536
    buffer_load_dwordx4 v7, s[44:47], s87 offen nt lds
    s_add_u32 m0, m0, 1024
    s_add_u32 s87, s87, 65536
    s_load_dwordx2 s[38:39], s[52:53], 0
    s_load_dwordx2 s[56:57], s[0:1], 32
    s_load_dwordx2 s[64:65], s[0:1], 64
    s_load_dwordx2 s[60:61], s[0:1], 48
    s_load_dwordx2 s[76:77], s[0:1], 56
    s_load_dwordx2 s[80:81], s[0:1], 72
    s_load_dwordx2 s[72:73], s[0:1], 80
    buffer_load_dwordx4 v4, s[44:47], s84 offen nt lds
    s_add_u32 m0, m0, 1024
    s_add_u32 s84, s84, 65536
    buffer_load_dwordx4 v5, s[44:47], s85 offen nt lds
    s_add_u32 m0, m0, 1024
    s_add_u32 s85, s85, 65536
    buffer_load_dwordx4 v6, s[44:47], s86 offen nt lds
    s_add_u32 m0, m0, 1024
    s_add_u32 s86, s86, 65536
    buffer_load_dwordx4 v7, s[44:47], s87 offen nt lds
    s_add_u32 m0, m0, 1024
    s_add_u32 s87, s87, 65536
    s_mul_i32 s35, s30, 7
    s_lshr_b32 s6, s31, 1
    s_add_u32 s35, s35, s6
    s_sub_u32 s35, s35, 8
    s_and_b32 s6, s31, 1
    s_add_u32 s6, s6, 2
    s_cmp_lt_u32 s31, 30
    s_cselect_b32 s36, s6, 0
    s_cmp_lt_u32 s31, 16
    s_cselect_b32 s36, 1, s36
    s_lshr_b32 s32, s31, 3
    s_lshl_b32 s6, s32, 1
    s_cmp_ge_u32 s30, 4
    s_cselect_b32 s36, 1, s36
    s_cselect_b32 s32, s32, s6
    s_lshl_b32 s33, s30, 2
    s_add_u32 s33, s33, s32
    v_and_b32 v9, 7, v0
    v_lshlrev_b32 v233, 4, v9
    s_waitcnt vmcnt(7)
    buffer_load_dwordx4 v4, s[44:47], s84 offen nt lds
    s_add_u32 m0, m0, 1024
    s_add_u32 s84, s84, 65536
    s_lshl_b32 s4, s30, 3
    s_add_u32 s4, s4, s89
    s_lshl_b32 s4, s4, 13
    s_lshl_b32 s90, s34, 11
    s_add_u32 s4, s4, s90
    s_add_u32 s4, s4, 3145728
    s_mov_b32 s40, 0x05040100
    s_mov_b32 s41, 0x07060302
    s_mov_b32 s42, 0x3e0293ee
    s_mov_b32 s43, 0x3f803f80
    s_mov_b32 s20, 0x000f000f
    s_mov_b32 s21, 0x000f000f
    s_mov_b32 s22, 0x00f000f0
    s_mov_b32 s23, 0x00f000f0
    s_mov_b32 s24, 0x0f000f00
    s_mov_b32 s25, 0x0f000f00
    s_mov_b32 s26, 0xf000f000
    s_mov_b32 s27, 0xf000f000
    s_mov_b32 s59, 0x00020000
    s_mov_b32 s78, 3584
    s_mov_b32 s79, 0x00020000
    s_mov_b32 s82, 1024
    s_mov_b32 s83, 0x00020000
    s_mov_b32 s74, 8192
    s_mov_b32 s75, 0x00020000
    s_mov_b32 s70, 8192
    s_mov_b32 s71, 0x00020000
    s_movk_i32 s90, 1024
    s_cmp_eq_u32 s36, 2
    s_cselect_b32 s90, 3584, s90
    v_lshrrev_b32 v8, 3, v0
    v_mul_lo_u32 v8, v8, s90
    v_and_b32 v9, 1, v1
    v_mul_u32_u24 v9, 48, v9
    v_xor_b32 v9, v9, v233
    v_add_u32 v233, v9, v8
    v_xor_b32 v9, 64, v9
    v_add_u32 v238, v9, v8
    s_lshl_b32 s6, s90, 3
    s_waitcnt vmcnt(7)
    buffer_load_dwordx4 v5, s[44:47], s85 offen nt lds
    s_add_u32 m0, m0, 1024
    s_add_u32 s85, s85, 65536
    v_and_b32 v8, 1, v1
    v_and_b32 v9, 1, v0
    v_lshl_add_u32 v8, v8, 1, v9
    v_and_b32 v9, 2, v0
    v_bfe_u32 v10, v0, 2, 1
    v_add_u32 v9, v9, v10
    v_lshlrev_b32 v9, 8, v9
    v_lshl_add_u32 v8, v8, 10, v9
    v_lshrrev_b32 v9, 5, v0
    v_lshl_add_u32 v8, v9, 4, v8
    v_and_b32 v9, 8, v0
    v_add_u32 v8, v8, v9
    s_lshl_b32 s90, s34, 6
    s_add_u32 s90, s90, 131072
    v_add_u32 v224, s90, v8
    v_and_b32 v11, 3, v2
    v_lshrrev_b32 v12, 2, v2
    v_lshlrev_b32 v9, 10, v11
    v_lshl_add_u32 v9, v12, 8, v9
    v_xor_b32 v10, v1, v2
    v_lshl_add_u32 v9, v10, 4, v9
    s_lshl_b32 s90, s34, 14
    v_add_u32 v243, s90, v9
    v_xor_b32 v244, 64, v243
    v_xor_b32 v245, 0x80, v243
    v_xor_b32 v246, 0xc0, v243
    v_lshlrev_b32 v8, 4, v11
    v_add_u32 v225, 145408, v8
    s_lshl_b32 s90, s34, 2
    v_add_u32 v226, s90, v225
    v_add_u32 v230, 64, v226
    s_lshl_b32 s90, s34, 4
    s_add_u32 s90, s90, 145408
    v_mov_b32 v227, s90
    v_add_u32 v231, 64, v227
    s_waitcnt vmcnt(7)
    buffer_load_dwordx4 v6, s[44:47], s86 offen nt lds
    s_add_u32 m0, m0, 1024
    s_add_u32 s86, s86, 65536
    v_mul_u32_u24 v8, 18, v11
    v_lshl_add_u32 v8, v1, 2, v8
    v_add_u32 v8, v8, v12
    s_mul_i32 s90, s34, 2560
    s_add_u32 s90, s90, 135168
    v_lshl_add_u32 v228, v8, 4, s90
    v_lshl_add_u32 v8, v1, 2, v11
    v_lshlrev_b32 v8, 4, v8
    v_lshl_add_u32 v8, v12, 2, v8
    s_mul_i32 s90, s34, 288
    s_add_u32 s90, s90, 135168
    v_add_u32 v229, s90, v8
    v_lshlrev_b32 v232, 2, v0
    s_lshl_b32 s9, s30, 15
    s_add_u32 s9, s9, 1572864
    s_lshl_b32 s7, s34, 13
    s_add_u32 s7, s7, s9
    s_lshl_b32 s91, s31, 6
    s_add_u32 s7, s7, s91
    v_lshlrev_b32 v8, 2, v2
    v_lshl_add_u32 v234, v1, 11, v8
    s_lshl_b32 s10, s30, 9
    s_add_u32 s10, s10, 8192
    s_lshl_b32 s91, s34, 7
    s_add_u32 s8, s10, s91
    s_lshl_b32 s90, s31, 2
    s_add_u32 s8, s8, s90
    s_lshr_b32 s98, s34, 1
    s_and_b32 s99, s34, 1
    s_cmp_lt_u32 s30, 4
    s_cselect_b32 s93, s99, 0
    s_add_u32 s93, s93, s32
    s_lshl_b32 s91, s93, 13
    s_add_u32 s9, s9, s91
    s_mov_b32 s90, s98
    s_lshl_b32 s91, s90, 10
    s_add_u32 s9, s9, s91
    s_add_u32 s92, s9, 4096
    s_lshl_b32 s90, s90, 6
    s_add_u32 s10, s10, s90
    s_lshl_b32 s90, s93, 7
    s_add_u32 s10, s10, s90
    s_waitcnt vmcnt(7)
    buffer_load_dwordx4 v7, s[44:47], s87 offen nt lds
    s_add_u32 m0, m0, 1024
    s_add_u32 s87, s87, 65536
    s_lshl_b32 s5, s30, 2
    s_add_u32 s5, s5, s32
    s_lshl_b32 s5, s5, 2
    s_add_u32 s5, s5, s34
    s_lshl_b32 s5, s5, 15
    s_and_b32 s91, s31, 7
    s_and_b32 s11, s91, 6
    s_add_u32 s11, s11, s91
    s_lshl_b32 s11, s11, 12
    s_lshl_b32 s91, s91, 7
    s_add_u32 s5, s5, s91
    s_lshl_b32 s90, s33, 7
    s_add_u32 s11, s11, s90
    s_lshr_b32 s90, s34, 1
    s_lshl_b32 s90, s90, 18
    s_add_u32 s11, s11, s90
    s_cmp_lt_u32 s30, 4
    s_cselect_b32 s90, 7, 6
    s_lshl_b32 s90, s99, s90
    s_add_u32 s11, s11, s90
    s_add_u32 s11, s11, 524288
    s_mul_i32 s90, s34, 458752
    s_lshl_b32 s91, s35, 7
    s_add_u32 s90, s90, s91
    s_cmp_eq_u32 s36, 2
    s_cselect_b32 s5, s90, s5
    s_lshl_b32 s90, s34, 4
    s_and_b32 s91, s31, 15
    s_add_u32 s90, s90, s91
    s_and_b32 s13, s90, 62
    s_add_u32 s13, s13, s90
    s_lshl_b32 s13, s13, 12
    s_add_u32 s15, s13, 1048576
    s_add_u32 s13, s13, 524288
    s_lshl_b32 s12, s90, 7
    s_lshl_b32 s14, s30, 13
    s_add_u32 s14, s14, 65536
    s_add_u32 s14, s14, s12
    s_waitcnt vmcnt(7)
    buffer_load_dwordx4 v4, s[44:47], s84 offen nt lds
    s_add_u32 m0, m0, 1024
    s_sub_u32 s84, s84, 196608
    v_lshl_add_u32 v9, v1, 3, v12
    v_lshlrev_b32 v9, 7, v9
    v_and_b32 v10, 1, v0
    v_lshl_add_u32 v9, v10, 3, v9
    v_bfe_u32 v8, v0, 3, 2
    v_lshl_add_u32 v9, v8, 5, v9
    v_and_b32 v8, 1, v8
    v_lshl_add_u32 v9, v8, 4, v9
    s_lshl_b32 s90, s34, 12
    s_add_u32 s90, s90, 65536
    s_lshl_b32 s91, s34, 14
    s_add_u32 s91, s91, 65536
    s_cmp_eq_u32 s36, 2
    s_cselect_b32 s19, s91, s90
    s_cselect_b32 s90, 4, 5
    v_bfe_u32 v8, v0, 1, 1
    v_lshlrev_b32 v8, s90, v8
    v_xor_b32 v9, v9, v8
    s_cmp_lt_u32 s30, 4
    s_cselect_b32 s90, 14, 6
    s_lshl_b32 s90, s99, s90
    s_or_b32 s90, s90, 65536
    s_cmp_eq_u32 s36, 2
    s_cselect_b32 s90, s91, s90
    v_xor_b32 v235, s90, v9
    s_cselect_b32 s90, 32, 16
    v_xor_b32 v239, s90, v235
    v_lshlrev_b32 v8, 6, v2
    v_lshl_add_u32 v236, v1, 4, v8
    v_lshlrev_b32 v237, 4, v1
    v_lshlrev_b32 v8, 16, v1
    v_lshl_add_u32 v240, v12, 4, v8
    v_and_b32 v15, 1, v1
    v_bfe_u32 v8, v0, 1, 2
    v_lshlrev_b32 v8, 5, v8
    v_lshl_add_u32 v8, v15, 4, v8
    v_and_b32 v9, 1, v0
    v_lshl_add_u32 v241, v9, 3, v8
    v_and_b32 v9, 1, v0
    v_lshlrev_b32 v8, 4, v9
    v_mov_b32 v10, 0x3f80
    v_lshlrev_b32 v8, v8, v10
    v_lshrrev_b32 v9, 1, v2
    v_cmp_eq_u32 vcc, 0, v9
    s_nop 1
    v_cndmask_b32 v88, 0, v8, vcc
    v_cmp_eq_u32 vcc, 1, v9
    s_nop 1
    v_cndmask_b32 v89, 0, v8, vcc
    v_cmp_eq_u32 vcc, 2, v9
    s_nop 1
    v_cndmask_b32 v90, 0, v8, vcc
    v_cmp_eq_u32 vcc, 3, v9
    s_nop 1
    v_cndmask_b32 v91, 0, v8, vcc
    s_waitcnt vmcnt(7)
    buffer_load_dwordx4 v5, s[44:47], s85 offen nt lds
    s_add_u32 m0, m0, 1024
    s_sub_u32 s85, s85, 196608
    s_waitcnt lgkmcnt(0)
    s_cmp_lg_u32 s36, 1
    s_cselect_b32 s58, 0, 4194304
    s_cmp_lg_u32 s36, 1
    s_cbranch_scc1 L_nosm
    s_cmp_ge_u32 s30, 4
    s_cbranch_scc1 L_nosm
    s_and_b32 s90, s12, 1023
    buffer_load_dwordx2 v[92:93], v241, s[68:71], s12 offen
    buffer_load_dwordx2 v[94:95], v241, s[80:83], s90 offen
L_nosm:
    s_getreg_b32 s91, hwreg(HW_REG_XCC_ID)
    s_add_u32 s38, s38, 1
    s_and_b32 s39, s39, 0x0fffffff
    s_lshl_b32 s91, s91, 28
    s_or_b32 s39, s39, s91
    s_waitcnt vmcnt(7)
    buffer_load_dwordx4 v6, s[44:47], s86 offen nt lds
    s_add_u32 m0, m0, 1024
    s_sub_u32 s86, s86, 196608
    s_waitcnt vmcnt(7)
    buffer_load_dwordx4 v7, s[44:47], s87 offen nt lds
    s_sub_u32 s87, s87, 196608
    s_waitcnt vmcnt(7)
    buffer_load_dwordx4 v[128:131], v247, s[48:51], s84 offen nt
    s_add_u32 s84, s84, 65536
    s_waitcnt vmcnt(7)
    buffer_load_dwordx4 v[132:135], v247, s[48:51], s85 offen nt
    s_add_u32 s85, s85, 65536
    s_waitcnt vmcnt(7)
    buffer_load_dwordx4 v[136:139], v247, s[48:51], s86 offen nt
    s_add_u32 s86, s86, 65536
    s_waitcnt vmcnt(7)
    buffer_load_dwordx4 v[140:143], v247, s[48:51], s87 offen nt
    s_add_u32 s87, s87, 65536
    s_waitcnt vmcnt(7)
    buffer_load_dwordx4 v[36:39], v3, s[52:55], s4 offen offset:0 sc1
    s_waitcnt vmcnt(7)
    buffer_load_dwordx4 v[40:43], v3, s[52:55], s4 offen offset:1024 sc1
    s_waitcnt vmcnt(7)
    buffer_load_dwordx4 v[144:147], v247, s[48:51], s84 offen nt
    s_add_u32 s84, s84, 65536
    s_waitcnt vmcnt(7)
    buffer_load_dwordx4 v[148:151], v247, s[48:51], s85 offen nt
    s_add_u32 s85, s85, 65536
    ds_read_b128 v[192:195], v243 offset:0
    ds_read_b128 v[196:199], v244 offset:0
    ds_read_b128 v[200:203], v245 offset:0
    ds_read_b128 v[204:207], v246 offset:0
    ds_read_b128 v[208:211], v243 offset:4096
    ds_read_b128 v[212:215], v244 offset:4096
    ds_read_b128 v[216:219], v245 offset:4096
    ds_read_b128 v[220:223], v246 offset:4096
    ds_read_b128 v[52:55], v243 offset:8192
    ds_read_b128 v[56:59], v244 offset:8192
    ds_read_b128 v[60:63], v245 offset:8192
    ds_read_b128 v[64:67], v246 offset:8192
    ds_read_b128 v[68:71], v243 offset:12288
    ds_read_b128 v[72:75], v244 offset:12288
    ds_read_b128 v[76:79], v245 offset:12288
    ds_read_b128 v[80:83], v246 offset:12288
    s_waitcnt vmcnt(7)
    buffer_load_dwordx4 v[152:155], v247, s[48:51], s86 offen nt
    s_add_u32 s86, s86, 65536
    s_waitcnt vmcnt(7)
    buffer_load_dwordx4 v[156:159], v247, s[48:51], s87 offen nt
    s_add_u32 s87, s87, 65536
    v_perm_b32 v96, v132, v128, s40
    v_perm_b32 v100, v132, v128, s41
    v_perm_b32 v104, v133, v129, s40
    v_perm_b32 v108, v133, v129, s41
    v_perm_b32 v112, v134, v130, s40
    v_perm_b32 v116, v134, v130, s41
    v_perm_b32 v120, v135, v131, s40
    v_perm_b32 v124, v135, v131, s41
    s_waitcnt vmcnt(7)
    buffer_load_dwordx4 v[160:163], v247, s[48:51], s84 offen nt
    s_add_u32 s84, s84, 65536
    s_waitcnt vmcnt(7)
    buffer_load_dwordx4 v[164:167], v247, s[48:51], s85 offen nt
    s_add_u32 s85, s85, 65536
    v_perm_b32 v97, v140, v136, s40
    v_perm_b32 v101, v140, v136, s41
    v_perm_b32 v105, v141, v137, s40
    v_perm_b32 v109, v141, v137, s41
    v_perm_b32 v113, v142, v138, s40
    v_perm_b32 v117, v142, v138, s41
    v_perm_b32 v121, v143, v139, s40
    v_perm_b32 v125, v143, v139, s41
    s_waitcnt vmcnt(7)
    buffer_load_dwordx4 v[168:171], v247, s[48:51], s86 offen nt
    s_add_u32 s86, s86, 65536
    s_waitcnt vmcnt(7)
    buffer_load_dwordx4 v[172:175], v247, s[48:51], s87 offen nt
    s_add_u32 s87, s87, 65536
    s_mov_b32 s94, 0
    v_xor_b32 v9, s39, v39
    v_xor_b32 v10, s39, v43
    v_or_b32 v9, v9, v10
    v_xor_b32 v10, s38, v38
    v_xor_b32 v11, s38, v42
    v_and_b32 v12, 0x0fffffff, v9
    v_or3_b32 v10, v10, v11, v12
    v_cmp_ne_u32 vcc, 0, v10
    s_nop 0
    s_cbranch_vccnz L_qnbn
    ds_write_b64 v224, v[36:37]
    ds_write_b64 v224, v[40:41] offset:32
    v_cmp_ne_u32 vcc, 0, v9
    s_nop 0
    s_cmp_eq_u64 vcc, 0
    s_cselect_b32 s90, 3, 1
    v_mov_b32 v9, s90
    ds_write_b32 v226, v9 offset:128
L_qnbrn:
    s_mov_b32 s29, 0x40000000
    s_cmp_lt_u32 s30, 4
    s_cselect_b32 s29, 106496, s29
    s_nop 0
    s_movk_i32 s28, 13312
    s_cmp_eq_u32 s36, 2
    s_cselect_b32 s28, 1024, s28
    s_cselect_b32 s29, 1073741824, s29
    s_mov_b32 m0, s19
    s_cmp_eq_u32 s94, 0
    s_cbranch_scc1 L_qdone
    buffer_load_dwordx4 v[176:179], v247, s[48:51], s84 offen nt
    buffer_load_dwordx4 v[180:183], v247, s[48:51], s85 offen nt
    buffer_load_dwordx4 v[184:187], v247, s[48:51], s86 offen nt
    buffer_load_dwordx4 v[188:191], v247, s[48:51], s87 offen nt
    s_waitcnt vmcnt(4)
L_qchk:
    v_xor_b32 v9, s39, v39
    v_xor_b32 v10, s39, v43
    v_or_b32 v9, v9, v10
    v_xor_b32 v10, s38, v38
    v_xor_b32 v11, s38, v42
    v_and_b32 v12, 0x0fffffff, v9
    v_or3_b32 v10, v10, v11, v12
    v_cmp_ne_u32 vcc, 0, v10
    s_nop 0
    s_cbranch_vccnz L_qretry
L_qok:
    ds_write_b64 v224, v[36:37]
    ds_write_b64 v224, v[40:41] offset:32
    v_cmp_ne_u32 vcc, 0, v9
    s_nop 0
    s_cmp_eq_u64 vcc, 0
    s_cselect_b32 s90, 3, 1
    v_mov_b32 v9, s90
    ds_write_b32 v226, v9 offset:128
L_qdone:
    v_add_u32 v8, 131072, v3
    s_mov_b32 s95, s94
    s_waitcnt lgkmcnt(0)
    s_barrier
    s_cmp_lg_u32 s95, 0
    s_cbranch_scc1 L_vn12
    s_waitcnt vmcnt(7)
    buffer_load_dwordx4 v[176:179], v247, s[48:51], s84 offen nt
L_vn12:
    ds_read_b128 v[20:23], v8 offset:0
    ds_read_b128 v[24:27], v8 offset:1024
    ds_read_b128 v[28:31], v8 offset:2048
    ds_read_b128 v[32:35], v8 offset:3072
    ds_read_b128 v[12:15], v225 offset:128
    v_mov_b32 v9, 145608
    ds_read_b32 v9, v9
    s_waitcnt lgkmcnt(5)
    v_mfma_f32_16x16x32_bf16 v[36:39], v[192:195], v[20:23], 0
    s_waitcnt lgkmcnt(4)
    v_mfma_f32_16x16x32_bf16 v[36:39], v[196:199], v[24:27], v[36:39]
    s_waitcnt lgkmcnt(3)
    v_mfma_f32_16x16x32_bf16 v[36:39], v[200:203], v[28:31], v[36:39]
    s_waitcnt lgkmcnt(2)
    v_mfma_f32_16x16x32_bf16 v[36:39], v[204:207], v[32:35], v[36:39]
    s_waitcnt lgkmcnt(0)
    v_mfma_f32_16x16x32_bf16 v[40:43], v[208:211], v[20:23], 0
    v_and_b32 v12, v12, v13
    v_and_b32 v14, v14, v15
    v_mfma_f32_16x16x32_bf16 v[40:43], v[212:215], v[24:27], v[40:43]
    v_and_b32 v12, v12, v14
    v_lshrrev_b32 v12, 1, v12
    v_mfma_f32_16x16x32_bf16 v[40:43], v[216:219], v[28:31], v[40:43]
    s_nop 0
    v_readfirstlane_b32 s37, v12
    v_mfma_f32_16x16x32_bf16 v[40:43], v[220:223], v[32:35], v[40:43]
    v_readfirstlane_b32 s99, v9
    s_nop 0
    v_mfma_f32_16x16x32_bf16 v[44:47], v[52:55], v[20:23], 0
    v_add_f32_dpp v36, v36, v36 row_ror:4 row_mask:0xf bank_mask:0xf
    v_add_f32_dpp v37, v37, v37 row_ror:4 row_mask:0xf bank_mask:0xf
    v_mfma_f32_16x16x32_bf16 v[44:47], v[56:59], v[24:27], v[44:47]
    v_add_f32_dpp v38, v38, v38 row_ror:4 row_mask:0xf bank_mask:0xf
    v_add_f32_dpp v39, v39, v39 row_ror:4 row_mask:0xf bank_mask:0xf
    v_mfma_f32_16x16x32_bf16 v[44:47], v[60:63], v[28:31], v[44:47]
    v_add_f32_dpp v36, v36, v36 row_ror:8 row_mask:0xf bank_mask:0xf
    v_add_f32_dpp v37, v37, v37 row_ror:8 row_mask:0xf bank_mask:0xf
    v_mfma_f32_16x16x32_bf16 v[44:47], v[64:67], v[32:35], v[44:47]
    v_add_f32_dpp v38, v38, v38 row_ror:8 row_mask:0xf bank_mask:0xf
    v_add_f32_dpp v39, v39, v39 row_ror:8 row_mask:0xf bank_mask:0xf
    v_mfma_f32_16x16x32_bf16 v[48:51], v[68:71], v[20:23], 0
    v_add_f32_dpp v40, v40, v40 row_ror:4 row_mask:0xf bank_mask:0xf
    v_add_f32_dpp v41, v41, v41 row_ror:4 row_mask:0xf bank_mask:0xf
    v_mfma_f32_16x16x32_bf16 v[48:51], v[72:75], v[24:27], v[48:51]
    v_add_f32_dpp v42, v42, v42 row_ror:4 row_mask:0xf bank_mask:0xf
    v_add_f32_dpp v43, v43, v43 row_ror:4 row_mask:0xf bank_mask:0xf
    v_mfma_f32_16x16x32_bf16 v[48:51], v[76:79], v[28:31], v[48:51]
    v_add_f32_dpp v40, v40, v40 row_ror:8 row_mask:0xf bank_mask:0xf
    v_add_f32_dpp v41, v41, v41 row_ror:8 row_mask:0xf bank_mask:0xf
    v_mfma_f32_16x16x32_bf16 v[48:51], v[80:83], v[32:35], v[48:51]
    v_add_f32_dpp v42, v42, v42 row_ror:8 row_mask:0xf bank_mask:0xf
    v_add_f32_dpp v43, v43, v43 row_ror:8 row_mask:0xf bank_mask:0xf
    s_add_u32 s11, s11, s99
    s_add_u32 s13, s13, s99
    s_add_u32 s15, s15, s99
    s_cmp_lg_u32 s95, 0
    s_cbranch_scc1 L_vn13
    s_waitcnt vmcnt(7)
    buffer_load_dwordx4 v[180:183], v247, s[48:51], s85 offen nt
L_vn13:
    v_add_f32_dpp v44, v44, v44 row_ror:4 row_mask:0xf bank_mask:0xf
    v_add_f32_dpp v45, v45, v45 row_ror:4 row_mask:0xf bank_mask:0xf
    v_add_f32_dpp v46, v46, v46 row_ror:4 row_mask:0xf bank_mask:0xf
    v_add_f32_dpp v47, v47, v47 row_ror:4 row_mask:0xf bank_mask:0xf
    v_max3_f32 v10, v36, v37, v38
    v_max3_f32 v11, v39, v40, v41
    v_add_f32_dpp v44, v44, v44 row_ror:8 row_mask:0xf bank_mask:0xf
    v_add_f32_dpp v45, v45, v45 row_ror:8 row_mask:0xf bank_mask:0xf
    v_add_f32_dpp v46, v46, v46 row_ror:8 row_mask:0xf bank_mask:0xf
    v_add_f32_dpp v47, v47, v47 row_ror:8 row_mask:0xf bank_mask:0xf
    v_add_f32_dpp v48, v48, v48 row_ror:4 row_mask:0xf bank_mask:0xf
    v_add_f32_dpp v49, v49, v49 row_ror:4 row_mask:0xf bank_mask:0xf
    v_add_f32_dpp v50, v50, v50 row_ror:4 row_mask:0xf bank_mask:0xf
    v_add_f32_dpp v51, v51, v51 row_ror:4 row_mask:0xf bank_mask:0xf
    v_max3_f32 v10, v10, v42, v43
    v_max3_f32 v11, v11, v44, v45
    v_add_f32_dpp v48, v48, v48 row_ror:8 row_mask:0xf bank_mask:0xf
    v_add_f32_dpp v49, v49, v49 row_ror:8 row_mask:0xf bank_mask:0xf
    v_add_f32_dpp v50, v50, v50 row_ror:8 row_mask:0xf bank_mask:0xf
    v_add_f32_dpp v51, v51, v51 row_ror:8 row_mask:0xf bank_mask:0xf
    v_max3_f32 v10, v10, v46, v47
    v_max3_f32 v11, v11, v48, v49
    v_max3_f32 v10, v10, v50, v51
    v_max_f32 v10, v10, v11
    v_mov_b32 v11, v10
    s_nop 1
    v_permlane16_swap_b32 v10, v11
    v_max_f32 v10, v10, v11
    v_mov_b32 v11, v10
    s_nop 1
    v_permlane32_swap_b32 v10, v11
    v_max_f32 v10, v10, v11
    ds_write_b32 v226, v10
    s_cmp_lg_u32 s95, 0
    s_cbranch_scc1 L_vn14
    s_waitcnt vmcnt(7)
    buffer_load_dwordx4 v[184:187], v247, s[48:51], s86 offen nt
L_vn14:
    v_mul_f32 v36, s42, v36
    v_mul_f32 v37, s42, v37
    v_mul_f32 v38, s42, v38
    v_mul_f32 v39, s42, v39
    v_mul_f32 v40, s42, v40
    v_mul_f32 v41, s42, v41
    v_mul_f32 v42, s42, v42
    v_mul_f32 v43, s42, v43
    v_mul_f32 v44, s42, v44
    v_mul_f32 v45, s42, v45
    v_mul_f32 v46, s42, v46
    v_mul_f32 v47, s42, v47
    v_mul_f32 v48, s42, v48
    v_mul_f32 v49, s42, v49
    v_mul_f32 v50, s42, v50
    v_mul_f32 v51, s42, v51
    s_waitcnt lgkmcnt(0)
    s_barrier
    s_cmp_lg_u32 s95, 0
    s_cbranch_scc1 L_vn15
    s_waitcnt vmcnt(7)
    buffer_load_dwordx4 v[188:191], v247, s[48:51], s87 offen nt
L_vn15:
    ds_read_b128 v[12:15], v225
    ds_read_b128 v[8:11], v227
    buffer_load_dwordx4 v233, s[56:59], s5 offen nt lds
    s_add_u32 m0, m0, 1024
    s_add_u32 s5, s5, s6
    buffer_load_dwordx4 v238, s[56:59], s5 offen nt lds
    s_waitcnt lgkmcnt(1)
    v_max3_f32 v12, v12, v13, v14
    v_max_f32 v12, v12, v15
    v_mul_f32 v12, s42, v12
    v_sub_f32 v36, v36, v12
    v_sub_f32 v37, v37, v12
    v_sub_f32 v38, v38, v12
    v_sub_f32 v39, v39, v12
    v_sub_f32 v40, v40, v12
    v_sub_f32 v41, v41, v12
    v_sub_f32 v42, v42, v12
    v_sub_f32 v43, v43, v12
    v_exp_f32 v36, v36
    v_exp_f32 v37, v37
    v_exp_f32 v38, v38
    v_exp_f32 v39, v39
    v_exp_f32 v40, v40
    v_exp_f32 v41, v41
    v_exp_f32 v42, v42
    v_exp_f32 v43, v43
    v_cvt_pk_bf16_f32 v68, v36, v37
    v_cvt_pk_bf16_f32 v69, v38, v39
    v_cvt_pk_bf16_f32 v70, v40, v41
    v_cvt_pk_bf16_f32 v71, v42, v43
    v_cndmask_b32 v52, 0, v68, s[20:21]
    v_cndmask_b32 v53, 0, v69, s[20:21]
    v_cndmask_b32 v54, 0, v70, s[20:21]
    v_cndmask_b32 v55, 0, v71, s[20:21]
    v_cndmask_b32 v56, 0, v68, s[22:23]
    v_cndmask_b32 v57, 0, v69, s[22:23]
    v_cndmask_b32 v58, 0, v70, s[22:23]
    v_cndmask_b32 v59, 0, v71, s[22:23]
    v_cndmask_b32 v60, 0, v68, s[24:25]
    v_cndmask_b32 v61, 0, v69, s[24:25]
    v_cndmask_b32 v62, 0, v70, s[24:25]
    v_cndmask_b32 v63, 0, v71, s[24:25]
    v_cndmask_b32 v64, 0, v68, s[26:27]
    v_cndmask_b32 v65, 0, v69, s[26:27]
    v_cndmask_b32 v66, 0, v70, s[26:27]
    v_cndmask_b32 v67, 0, v71, s[26:27]
    s_waitcnt vmcnt(12)
    v_perm_b32 v98, v148, v144, s40
    v_perm_b32 v102, v148, v144, s41
    v_perm_b32 v106, v149, v145, s40
    v_perm_b32 v110, v149, v145, s41
    v_perm_b32 v114, v150, v146, s40
    v_perm_b32 v118, v150, v146, s41
    v_perm_b32 v122, v151, v147, s40
    v_perm_b32 v126, v151, v147, s41
    s_waitcnt vmcnt(10)
    v_perm_b32 v99, v156, v152, s40
    v_perm_b32 v103, v156, v152, s41
    v_perm_b32 v107, v157, v153, s40
    v_perm_b32 v111, v157, v153, s41
    v_perm_b32 v115, v158, v154, s40
    v_perm_b32 v119, v158, v154, s41
    v_perm_b32 v123, v159, v155, s40
    v_perm_b32 v127, v159, v155, s41
    v_mfma_f32_16x16x32_bf16 v[80:83], v[96:99], v[52:55], 0
    v_sub_f32 v44, v44, v12
    v_sub_f32 v45, v45, v12
    v_sub_f32 v46, v46, v12
    v_sub_f32 v47, v47, v12
    v_mfma_f32_16x16x32_bf16 v[84:87], v[100:103], v[52:55], 0
    v_sub_f32 v48, v48, v12
    v_sub_f32 v49, v49, v12
    v_sub_f32 v50, v50, v12
    v_sub_f32 v51, v51, v12
    v_mfma_f32_16x16x32_bf16 v[80:83], v[104:107], v[56:59], v[80:83]
    v_exp_f32 v44, v44
    v_exp_f32 v45, v45
    v_mfma_f32_16x16x32_bf16 v[84:87], v[108:111], v[56:59], v[84:87]
    v_exp_f32 v46, v46
    v_exp_f32 v47, v47
    v_mfma_f32_16x16x32_bf16 v[80:83], v[112:115], v[60:63], v[80:83]
    v_exp_f32 v48, v48
    v_exp_f32 v49, v49
    v_mfma_f32_16x16x32_bf16 v[84:87], v[116:119], v[60:63], v[84:87]
    v_exp_f32 v50, v50
    v_exp_f32 v51, v51
    v_mfma_f32_16x16x32_bf16 v[80:83], v[120:123], v[64:67], v[80:83]
    v_cvt_pk_bf16_f32 v72, v44, v45
    v_cvt_pk_bf16_f32 v73, v46, v47
    v_mfma_f32_16x16x32_bf16 v[84:87], v[124:127], v[64:67], v[84:87]
    v_cvt_pk_bf16_f32 v74, v48, v49
    v_cvt_pk_bf16_f32 v75, v50, v51
    v_cndmask_b32 v20, 0, v72, s[20:21]
    v_cndmask_b32 v21, 0, v73, s[20:21]
    v_cndmask_b32 v22, 0, v74, s[20:21]
    v_cndmask_b32 v23, 0, v75, s[20:21]
    v_cndmask_b32 v24, 0, v72, s[22:23]
    v_cndmask_b32 v25, 0, v73, s[22:23]
    v_cndmask_b32 v26, 0, v74, s[22:23]
    v_cndmask_b32 v27, 0, v75, s[22:23]
    v_cndmask_b32 v28, 0, v72, s[24:25]
    v_cndmask_b32 v29, 0, v73, s[24:25]
    v_cndmask_b32 v30, 0, v74, s[24:25]
    v_cndmask_b32 v31, 0, v75, s[24:25]
    v_cndmask_b32 v32, 0, v72, s[26:27]
    v_cndmask_b32 v33, 0, v73, s[26:27]
    v_cndmask_b32 v34, 0, v74, s[26:27]
    v_cndmask_b32 v35, 0, v75, s[26:27]
    v_mov_b32 v4, s43
    v_mov_b32 v5, s43
    v_mov_b32 v6, s43
    v_mov_b32 v7, s43
    s_waitcnt lgkmcnt(0)
    v_max3_f32 v8, v8, v9, v10
    v_max_f32 v8, v8, v11
    v_mul_f32 v242, s42, v8
    v_mfma_f32_16x16x32_bf16 v[76:79], v[4:7], v[68:71], 0
    v_mfma_f32_16x16x32_bf16 v[76:79], v[4:7], v[72:75], v[76:79]
    s_add_u32 m0, m0, 1024
    s_add_u32 s5, s5, s6
    buffer_load_dwordx4 v233, s[56:59], s5 offen nt lds
    s_add_u32 m0, m0, 1024
    s_add_u32 s5, s5, s6
    buffer_load_dwordx4 v238, s[56:59], s5 offen nt lds
    s_waitcnt vmcnt(10)
    v_perm_b32 v192, v164, v160, s40
    v_perm_b32 v196, v164, v160, s41
    v_perm_b32 v200, v165, v161, s40
    v_perm_b32 v204, v165, v161, s41
    v_perm_b32 v208, v166, v162, s40
    v_perm_b32 v212, v166, v162, s41
    v_perm_b32 v216, v167, v163, s40
    v_perm_b32 v220, v167, v163, s41
    ds_write_b32 v230, v76
    s_add_u32 m0, m0, s28
    s_add_u32 s5, s5, s29
    buffer_load_dwordx4 v233, s[56:59], s5 offen nt lds
    s_add_u32 m0, m0, 1024
    s_add_u32 s5, s5, s6
    buffer_load_dwordx4 v238, s[56:59], s5 offen nt lds
    s_waitcnt vmcnt(10)
    v_perm_b32 v193, v172, v168, s40
    v_perm_b32 v197, v172, v168, s41
    v_perm_b32 v201, v173, v169, s40
    v_perm_b32 v205, v173, v169, s41
    v_perm_b32 v209, v174, v170, s40
    v_perm_b32 v213, v174, v170, s41
    v_perm_b32 v217, v175, v171, s40
    v_perm_b32 v221, v175, v171, s41
    s_add_u32 m0, m0, 1024
    s_add_u32 s5, s5, s6
    buffer_load_dwordx4 v233, s[56:59], s5 offen nt lds
    s_add_u32 m0, m0, 1024
    s_add_u32 s5, s5, s6
    buffer_load_dwordx4 v238, s[56:59], s5 offen nt lds
    s_waitcnt vmcnt(10)
    v_perm_b32 v194, v180, v176, s40
    v_perm_b32 v198, v180, v176, s41
    v_perm_b32 v202, v181, v177, s40
    v_perm_b32 v206, v181, v177, s41
    v_perm_b32 v210, v182, v178, s40
    v_perm_b32 v214, v182, v178, s41
    v_perm_b32 v218, v183, v179, s40
    v_perm_b32 v222, v183, v179, s41
    s_waitcnt vmcnt(8)
    v_perm_b32 v195, v188, v184, s40
    v_perm_b32 v199, v188, v184, s41
    v_perm_b32 v203, v189, v185, s40
    v_mfma_f32_16x16x32_bf16 v[80:83], v[192:195], v[20:23], v[80:83]
    v_perm_b32 v207, v189, v185, s41
    v_mfma_f32_16x16x32_bf16 v[84:87], v[196:199], v[20:23], v[84:87]
    v_perm_b32 v211, v190, v186, s40
    v_mfma_f32_16x16x32_bf16 v[80:83], v[200:203], v[24:27], v[80:83]
    v_perm_b32 v215, v190, v186, s41
    v_mfma_f32_16x16x32_bf16 v[84:87], v[204:207], v[24:27], v[84:87]
    v_perm_b32 v219, v191, v187, s40
    v_mfma_f32_16x16x32_bf16 v[80:83], v[208:211], v[28:31], v[80:83]
    v_perm_b32 v223, v191, v187, s41
    v_mfma_f32_16x16x32_bf16 v[84:87], v[212:215], v[28:31], v[84:87]
    v_mfma_f32_16x16x32_bf16 v[80:83], v[216:219], v[32:35], v[80:83]
    v_mfma_f32_16x16x32_bf16 v[84:87], v[220:223], v[32:35], v[84:87]
    s_nop 6
    ds_write_b128 v228, v[80:83]
    ds_write_b128 v228, v[84:87] offset:1280
    s_waitcnt lgkmcnt(0)
    s_barrier
    ds_read_b128 v[12:15], v231
    ds_read2st64_b32 v[36:37], v229 offset0:0 offset1:5
    ds_read2st64_b32 v[38:39], v229 offset0:10 offset1:15
    ds_read2st64_b32 v[40:41], v229 offset0:20 offset1:25
    ds_read2st64_b32 v[42:43], v229 offset0:30 offset1:35
    s_cmp_eq_u32 s37, 0
    s_waitcnt lgkmcnt(4)
    v_add_f32 v12, v12, v13
    v_add_f32 v14, v14, v15
    v_add_f32 v12, v12, v14
    v_rcp_f32 v13, v12
    v_log_f32 v14, v12
    s_waitcnt lgkmcnt(2)
    v_pk_add_f32 v[36:37], v[36:37], v[38:39]
    s_waitcnt lgkmcnt(0)
    v_pk_add_f32 v[40:41], v[40:41], v[42:43]
    v_add_f32 v14, v14, v242
    v_pk_add_f32 v[36:37], v[36:37], v[40:41]
    v_mul_f32 v36, v36, v13
    v_mul_f32 v37, v37, v13
    v_cvt_pk_bf16_f32 v36, v36, v37
    s_cbranch_scc1 L_a1g
    buffer_store_dword v36, v234, s[52:55], s7 offen
    s_mov_b64 exec, 1
    buffer_store_dword v14, v232, s[52:55], s8 offen
L_a1d:
    s_mov_b64 exec, -1
    s_cmp_lg_u32 s36, 1
    s_cbranch_scc1 L_notw
    s_cmp_lt_u32 s30, 4
    s_cbranch_scc1 L_w2
    buffer_load_dwordx4 v[52:55], v237, s[52:55], s10 offen sc1
    buffer_load_dwordx4 v[36:39], v236, s[52:55], s9 offen offset:0 sc1
    buffer_load_dwordx4 v[40:43], v236, s[52:55], s9 offen offset:2048 sc1
    buffer_load_dwordx4 v[44:47], v236, s[52:55], s92 offen offset:0 sc1
    buffer_load_dwordx4 v[48:51], v236, s[52:55], s92 offen offset:2048 sc1
    s_mov_b32 s94, 0
    s_mov_b32 s88, 0x11111111
    s_mov_b32 s89, 0x11111111
    s_waitcnt vmcnt(11)
    s_barrier
    ds_read_b64_tr_b16 v[128:129], v235 offset:0
    ds_read_b64_tr_b16 v[130:131], v235 offset:512
    ds_read_b64_tr_b16 v[132:133], v239 offset:0
    ds_read_b64_tr_b16 v[134:135], v239 offset:512
    ds_read_b64_tr_b16 v[136:137], v235 offset:4096
    ds_read_b64_tr_b16 v[138:139], v235 offset:4608
    ds_read_b64_tr_b16 v[140:141], v239 offset:4096
    ds_read_b64_tr_b16 v[142:143], v239 offset:4608
    ds_read_b64_tr_b16 v[144:145], v235 offset:8192
    ds_read_b64_tr_b16 v[146:147], v235 offset:8704
    ds_read_b64_tr_b16 v[148:149], v239 offset:8192
    ds_read_b64_tr_b16 v[150:151], v239 offset:8704
    ds_read_b64_tr_b16 v[152:153], v235 offset:12288
    ds_read_b64_tr_b16 v[154:155], v235 offset:12800
    ds_read_b64_tr_b16 v[156:157], v239 offset:12288
    ds_read_b64_tr_b16 v[158:159], v239 offset:12800
L_wchka:
    s_waitcnt vmcnt(0) lgkmcnt(0)
L_wgoa:
    v_mfma_f32_16x16x32_bf16 v[96:99], v[36:39], v[128:131], 0
    v_max3_u32 v9, v36, v37, v38
    v_max3_u32 v9, v9, v39, v40
    v_max3_u32 v9, v9, v41, v42
    v_mfma_f32_16x16x32_bf16 v[100:103], v[36:39], v[132:135], 0
    v_max3_u32 v9, v9, v43, v44
    v_max3_u32 v9, v9, v45, v46
    v_max3_u32 v9, v9, v47, v48
    v_mfma_f32_16x16x32_bf16 v[96:99], v[40:43], v[136:139], v[96:99]
    v_max3_u32 v9, v9, v49, v50
    v_max_u32 v9, v9, v51
    v_max3_u32 v8, v52, v53, v54
    v_mfma_f32_16x16x32_bf16 v[100:103], v[40:43], v[140:143], v[100:103]
    v_max_u32 v8, v8, v55
    v_cmp_eq_u32 s[20:21], -1, v9
    v_cmp_eq_u32 vcc, -1, v8
    v_mfma_f32_16x16x32_bf16 v[96:99], v[44:47], v[144:147], v[96:99]
    v_max3_f32 v8, v52, v53, v54
    v_max_f32 v8, v8, v55
    v_sub_f32 v12, v52, v8
    v_mfma_f32_16x16x32_bf16 v[100:103], v[44:47], v[148:151], v[100:103]
    v_sub_f32 v13, v53, v8
    v_sub_f32 v14, v54, v8
    v_sub_f32 v15, v55, v8
    v_mfma_f32_16x16x32_bf16 v[96:99], v[48:51], v[152:155], v[96:99]
    v_exp_f32 v12, v12
    v_exp_f32 v13, v13
    v_mfma_f32_16x16x32_bf16 v[100:103], v[48:51], v[156:159], v[100:103]
    v_exp_f32 v14, v14
    v_exp_f32 v15, v15
    s_or_b64 vcc, vcc, s[20:21]
    s_cbranch_scc1 L_wretrya
L_woka:
    v_add_f32 v8, v12, v13
    v_add_f32 v9, v14, v15
    v_mul_f32 v10, v12, v96
    s_nop 0
    v_mul_f32 v11, v12, v100
    v_add_f32 v8, v8, v9
    v_fmac_f32 v10, v13, v97
    v_fmac_f32 v11, v13, v101
    v_rcp_f32 v8, v8
    v_fmac_f32 v10, v14, v98
    v_fmac_f32 v11, v14, v102
    v_fmac_f32 v10, v15, v99
    v_fmac_f32 v11, v15, v103
    v_mul_f32 v10, v10, v8
    v_mul_f32 v11, v11, v8
    s_nop 0
    v_mov_b32_dpp v9, v10 row_shl:1 row_mask:0xf bank_mask:0xf
    v_mov_b32_dpp v7, v11 row_shl:1 row_mask:0xf bank_mask:0xf
    v_cvt_pk_bf16_f32 v20, v10, v9
    v_cvt_pk_bf16_f32 v22, v11, v7
    s_nop 0
    v_mov_b32_dpp v21, v20 row_shl:2 row_mask:0xf bank_mask:0xf
    v_mov_b32_dpp v23, v22 row_shl:2 row_mask:0xf bank_mask:0xf
    s_mov_b64 exec, s[88:89]
    buffer_store_dwordx4 v[20:23], v240, s[52:55], s11 offen offset:0 sc1
    s_mov_b64 exec, -1
    s_branch L_exit
L_wretrya:
    s_cmp_gt_u32 s94, 60000
    s_cbranch_scc1 L_woka
    buffer_load_dwordx4 v[52:55], v237, s[52:55], s10 offen sc1
    s_mov_b64 exec, s[20:21]
    s_cbranch_execz L_wga
    buffer_load_dwordx4 v[36:39], v236, s[52:55], s9 offen offset:0 sc1
    buffer_load_dwordx4 v[40:43], v236, s[52:55], s9 offen offset:2048 sc1
    buffer_load_dwordx4 v[44:47], v236, s[52:55], s92 offen offset:0 sc1
    buffer_load_dwordx4 v[48:51], v236, s[52:55], s92 offen offset:2048 sc1
L_wga:
    s_mov_b64 exec, -1
    s_add_u32 s94, s94, 1
    s_branch L_wchka
L_w2:
    buffer_load_dwordx4 v[52:55], v237, s[52:55], s10 offen sc1
    buffer_load_dwordx4 v[36:39], v236, s[52:55], s9 offen offset:0 sc1
    buffer_load_dwordx4 v[40:43], v236, s[52:55], s9 offen offset:2048 sc1
    buffer_load_dwordx4 v[44:47], v236, s[52:55], s92 offen offset:0 sc1
    buffer_load_dwordx4 v[48:51], v236, s[52:55], s92 offen offset:2048 sc1
    s_mov_b32 s94, 0
    s_mov_b32 s88, 0x11111111
    s_mov_b32 s89, 0x11111111
    v_xor_b32 v16, 64, v235
    v_xor_b32 v17, 64, v239
    s_waitcnt vmcnt(7)
    s_barrier
    ds_read_b64_tr_b16 v[128:129], v235 offset:0
    ds_read_b64_tr_b16 v[130:131], v235 offset:512
    ds_read_b64_tr_b16 v[132:133], v239 offset:0
    ds_read_b64_tr_b16 v[134:135], v239 offset:512
    ds_read_b64_tr_b16 v[136:137], v16 offset:0
    ds_read_b64_tr_b16 v[138:139], v16 offset:512
    ds_read_b64_tr_b16 v[140:141], v17 offset:0
    ds_read_b64_tr_b16 v[142:143], v17 offset:512
    ds_read_b64_tr_b16 v[144:145], v235 offset:4096
    ds_read_b64_tr_b16 v[146:147], v235 offset:4608
    ds_read_b64_tr_b16 v[148:149], v239 offset:4096
    ds_read_b64_tr_b16 v[150:151], v239 offset:4608
    ds_read_b64_tr_b16 v[152:153], v16 offset:4096
    ds_read_b64_tr_b16 v[154:155], v16 offset:4608
    ds_read_b64_tr_b16 v[156:157], v17 offset:4096
    ds_read_b64_tr_b16 v[158:159], v17 offset:4608
    ds_read_b64_tr_b16 v[160:161], v235 offset:8192
    ds_read_b64_tr_b16 v[162:163], v235 offset:8704
    ds_read_b64_tr_b16 v[164:165], v239 offset:8192
    ds_read_b64_tr_b16 v[166:167], v239 offset:8704
    ds_read_b64_tr_b16 v[168:169], v16 offset:8192
    ds_read_b64_tr_b16 v[170:171], v16 offset:8704
    ds_read_b64_tr_b16 v[172:173], v17 offset:8192
    ds_read_b64_tr_b16 v[174:175], v17 offset:8704
    ds_read_b64_tr_b16 v[176:177], v235 offset:12288
    ds_read_b64_tr_b16 v[178:179], v235 offset:12800
    ds_read_b64_tr_b16 v[180:181], v239 offset:12288
    ds_read_b64_tr_b16 v[182:183], v239 offset:12800
    ds_read_b64_tr_b16 v[184:185], v16 offset:12288
    ds_read_b64_tr_b16 v[186:187], v16 offset:12800
    ds_read_b64_tr_b16 v[188:189], v17 offset:12288
    ds_read_b64_tr_b16 v[190:191], v17 offset:12800
L_wchkb:
    s_waitcnt vmcnt(0) lgkmcnt(0)
L_wgob:
    v_mfma_f32_16x16x32_bf16 v[96:99], v[36:39], v[128:131], 0
    v_max3_u32 v9, v36, v37, v38
    v_max3_u32 v9, v9, v39, v40
    v_max3_u32 v9, v9, v41, v42
    v_mfma_f32_16x16x32_bf16 v[100:103], v[36:39], v[132:135], 0
    v_max3_u32 v9, v9, v43, v44
    v_max3_u32 v9, v9, v45, v46
    v_max3_u32 v9, v9, v47, v48
    v_mfma_f32_16x16x32_bf16 v[96:99], v[40:43], v[144:147], v[96:99]
    v_max3_u32 v9, v9, v49, v50
    v_max_u32 v9, v9, v51
    v_max3_u32 v8, v52, v53, v54
    v_mfma_f32_16x16x32_bf16 v[100:103], v[40:43], v[148:151], v[100:103]
    v_max_u32 v8, v8, v55
    v_cmp_eq_u32 s[20:21], -1, v9
    v_cmp_eq_u32 vcc, -1, v8
    v_mfma_f32_16x16x32_bf16 v[96:99], v[44:47], v[160:163], v[96:99]
    v_max3_f32 v8, v52, v53, v54
    v_max_f32 v8, v8, v55
    v_sub_f32 v12, v52, v8
    v_mfma_f32_16x16x32_bf16 v[100:103], v[44:47], v[164:167], v[100:103]
    v_sub_f32 v13, v53, v8
    v_sub_f32 v14, v54, v8
    v_sub_f32 v15, v55, v8
    v_mfma_f32_16x16x32_bf16 v[96:99], v[48:51], v[176:179], v[96:99]
    v_exp_f32 v12, v12
    v_exp_f32 v13, v13
    v_mfma_f32_16x16x32_bf16 v[100:103], v[48:51], v[180:183], v[100:103]
    v_exp_f32 v14, v14
    v_exp_f32 v15, v15
    s_or_b64 vcc, vcc, s[20:21]
    s_cbranch_scc1 L_wretryb
L_wokb:
    v_mfma_f32_16x16x32_bf16 v[104:107], v[36:39], v[136:139], 0
    v_add_f32 v8, v12, v13
    v_add_f32 v9, v14, v15
    v_mul_f32 v10, v12, v96
    v_mfma_f32_16x16x32_bf16 v[108:111], v[36:39], v[140:143], 0
    v_mul_f32 v11, v12, v100
    v_add_f32 v8, v8, v9
    v_fmac_f32 v10, v13, v97
    v_mfma_f32_16x16x32_bf16 v[104:107], v[40:43], v[152:155], v[104:107]
    v_fmac_f32 v11, v13, v101
    v_rcp_f32 v8, v8
    v_fmac_f32 v10, v14, v98
    v_mfma_f32_16x16x32_bf16 v[108:111], v[40:43], v[156:159], v[108:111]
    v_fmac_f32 v11, v14, v102
    v_fmac_f32 v10, v15, v99
    v_fmac_f32 v11, v15, v103
    v_mfma_f32_16x16x32_bf16 v[104:107], v[44:47], v[168:171], v[104:107]
    v_mul_f32 v10, v10, v8
    v_mul_f32 v11, v11, v8
    s_nop 0
    v_mfma_f32_16x16x32_bf16 v[108:111], v[44:47], v[172:175], v[108:111]
    v_mov_b32_dpp v9, v10 row_shl:1 row_mask:0xf bank_mask:0xf
    v_mov_b32_dpp v7, v11 row_shl:1 row_mask:0xf bank_mask:0xf
    v_cvt_pk_bf16_f32 v20, v10, v9
    v_mfma_f32_16x16x32_bf16 v[104:107], v[48:51], v[184:187], v[104:107]
    v_cvt_pk_bf16_f32 v22, v11, v7
    s_nop 0
    v_mov_b32_dpp v21, v20 row_shl:2 row_mask:0xf bank_mask:0xf
    v_mfma_f32_16x16x32_bf16 v[108:111], v[48:51], v[188:191], v[108:111]
    v_mov_b32_dpp v23, v22 row_shl:2 row_mask:0xf bank_mask:0xf
    s_mov_b64 exec, s[88:89]
    buffer_store_dwordx4 v[20:23], v240, s[52:55], s11 offen offset:0 sc1
    s_mov_b64 exec, -1
    v_mul_f32 v10, v12, v104
    s_nop 2
    v_mul_f32 v11, v12, v108
    v_fmac_f32 v10, v13, v105
    v_fmac_f32 v11, v13, v109
    v_fmac_f32 v10, v14, v106
    v_fmac_f32 v11, v14, v110
    v_fmac_f32 v10, v15, v107
    v_fmac_f32 v11, v15, v111
    v_mul_f32 v10, v10, v8
    v_mul_f32 v11, v11, v8
    s_nop 0
    v_mov_b32_dpp v9, v10 row_shl:1 row_mask:0xf bank_mask:0xf
    v_mov_b32_dpp v7, v11 row_shl:1 row_mask:0xf bank_mask:0xf
    v_cvt_pk_bf16_f32 v24, v10, v9
    v_cvt_pk_bf16_f32 v26, v11, v7
    s_nop 0
    v_mov_b32_dpp v25, v24 row_shl:2 row_mask:0xf bank_mask:0xf
    v_mov_b32_dpp v27, v26 row_shl:2 row_mask:0xf bank_mask:0xf
    s_mov_b64 exec, s[88:89]
    buffer_store_dwordx4 v[24:27], v240, s[52:55], s11 offen offset:64 sc1
    s_mov_b64 exec, -1
    v_lshlrev_b32 v12, 5, v0
    s_mov_b32 s88, 4096
    s_mov_b32 s94, 0
L_tg:
    buffer_load_dwordx4 v[36:39], v12, s[52:55], s88 offen sc1
    buffer_load_dwordx4 v[40:43], v12, s[52:55], s88 offen offset:16 sc1
    s_waitcnt vmcnt(0)
    v_xor_b32 v13, s39, v37
    v_xor_b32 v14, s39, v39
    v_xor_b32 v15, s39, v41
    v_or3_b32 v13, v13, v14, v15
    v_xor_b32 v14, s39, v43
    v_or_b32 v13, v13, v14
    v_and_b32 v13, 0x0fffffff, v13
    v_xor_b32 v14, s38, v36
    v_xor_b32 v15, s38, v38
    v_or3_b32 v13, v13, v14, v15
    v_xor_b32 v14, s38, v40
    v_xor_b32 v15, s38, v42
    v_or3_b32 v13, v13, v14, v15
    v_cmp_ne_u32 vcc, 0, v13
    s_nop 0
    s_cbranch_vccz L_tgok
    s_add_u32 s94, s94, 1
    s_cmp_le_u32 s94, 60000
    s_cbranch_scc1 L_tg
L_tgok:
    v_lshlrev_b32 v52, 16, v92
    v_and_b32 v53, 0xffff0000, v92
    v_lshlrev_b32 v54, 16, v93
    v_and_b32 v55, 0xffff0000, v93
    v_lshlrev_b32 v56, 16, v94
    v_and_b32 v57, 0xffff0000, v94
    v_lshlrev_b32 v58, 16, v95
    v_and_b32 v59, 0xffff0000, v95
    s_mov_b32 s88, 0x00ff00ff
    s_mov_b32 s89, 0
    s_mov_b64 s[20:21], -1
    s_mov_b64 s[22:23], -1
    s_mov_b64 s[24:25], -1
    s_mov_b32 s26, -1
    s_mov_b32 s27, -1
    s_mov_b32 s94, 0
L_g2:
    s_mov_b64 exec, s[20:21]
    s_cbranch_execz L_g2_0
    buffer_load_dwordx4 v[96:99], v3, s[52:55], s13 offen offset:0 sc1
L_g2_0:
    s_mov_b64 exec, s[22:23]
    s_cbranch_execz L_g2_1
    buffer_load_dwordx4 v[100:103], v3, s[52:55], s13 offen offset:1024 sc1
L_g2_1:
    s_mov_b64 exec, s[24:25]
    s_cbranch_execz L_g2_2
    buffer_load_dwordx4 v[104:107], v3, s[52:55], s13 offen offset:2048 sc1
L_g2_2:
    s_mov_b64 exec, s[26:27]
    s_cbranch_execz L_g2_3
    buffer_load_dwordx4 v[108:111], v3, s[52:55], s13 offen offset:3072 sc1
L_g2_3:
    s_mov_b64 exec, -1
    s_add_u32 s94, s94, 1
    s_waitcnt vmcnt(0)
    v_mfma_f32_16x16x32_bf16 v[12:15], v[88:91], v[96:99], 0
    v_max3_u32 v8, v96, v97, v98
    v_max_u32 v8, v8, v99
    v_mfma_f32_16x16x32_bf16 v[12:15], v[88:91], v[100:103], v[12:15]
    v_max3_u32 v9, v100, v101, v102
    v_max_u32 v9, v9, v103
    v_mfma_f32_16x16x32_bf16 v[12:15], v[88:91], v[104:107], v[12:15]
    v_max3_u32 v10, v104, v105, v106
    v_max_u32 v10, v10, v107
    v_mfma_f32_16x16x32_bf16 v[12:15], v[88:91], v[108:111], v[12:15]
    v_max3_u32 v11, v108, v109, v110
    v_max_u32 v11, v11, v111
    v_max3_u32 v16, v8, v9, v10
    v_max_u32 v16, v16, v11
    v_cmp_eq_u32 vcc, -1, v16
    s_nop 0
    s_cbranch_vccz L_g2ok
    v_cmp_eq_u32 s[20:21], -1, v8
    v_cmp_eq_u32 s[22:23], -1, v9
    v_cmp_eq_u32 s[24:25], -1, v10
    v_cmp_eq_u32 s[26:27], -1, v11
    s_cmp_le_u32 s94, 60000
    s_cbranch_scc1 L_g2
L_g2ok:
    s_cmp_eq_u32 s37, 0
    v_add_f32_dpp v12, v12, v12 row_ror:8 row_mask:0xf bank_mask:0xf
    v_add_f32_dpp v13, v13, v13 row_ror:8 row_mask:0xf bank_mask:0xf
    v_add_f32_dpp v14, v14, v14 row_ror:8 row_mask:0xf bank_mask:0xf
    v_add_f32_dpp v15, v15, v15 row_ror:8 row_mask:0xf bank_mask:0xf
    v_pk_add_f32 v[12:13], v[12:13], v[52:53]
    v_pk_add_f32 v[14:15], v[14:15], v[54:55]
    v_cvt_pk_bf16_f32 v92, v12, v13
    v_cvt_pk_bf16_f32 v93, v14, v15
    s_mov_b64 exec, s[88:89]
    s_cbranch_scc1 L_hg
    buffer_store_dwordx2 v[92:93], v241, s[52:55], s14 offen
L_hd:
    s_mov_b64 exec, -1
    s_cmp_lg_u32 s34, s30
    s_cbranch_scc1 L_exit
    v_lshlrev_b32 v52, 16, v92
    v_and_b32 v53, 0xffff0000, v92
    v_lshlrev_b32 v54, 16, v93
    v_and_b32 v55, 0xffff0000, v93
    s_waitcnt vmcnt(0)
    v_mov_b32 v108, 0
    v_mov_b32 v109, 0
    v_mov_b32 v110, 0
    v_mov_b32 v111, 0
    v_pk_add_f32 v[52:53], v[52:53], v[56:57]
    v_pk_add_f32 v[54:55], v[54:55], v[58:59]
    s_mov_b64 s[20:21], -1
    s_mov_b64 s[22:23], -1
    s_mov_b64 s[24:25], -1
    s_mov_b32 s26, -1
    s_mov_b32 s27, 0
    s_mov_b32 s94, 0
L_p2:
    s_mov_b64 exec, s[20:21]
    s_cbranch_execz L_p2_0
    buffer_load_dwordx4 v[96:99], v3, s[52:55], s15 offen offset:0 sc1
L_p2_0:
    s_mov_b64 exec, s[22:23]
    s_cbranch_execz L_p2_1
    buffer_load_dwordx4 v[100:103], v3, s[52:55], s15 offen offset:1024 sc1
L_p2_1:
    s_mov_b64 exec, s[24:25]
    s_cbranch_execz L_p2_2
    buffer_load_dwordx4 v[104:107], v3, s[52:55], s15 offen offset:2048 sc1
L_p2_2:
    s_mov_b64 exec, s[26:27]
    s_cbranch_execz L_p2_3
    buffer_load_dwordx4 v[108:111], v3, s[52:55], s15 offen offset:3072 sc1
L_p2_3:
    s_mov_b64 exec, -1
    s_add_u32 s94, s94, 1
    s_waitcnt vmcnt(0)
    v_mfma_f32_16x16x32_bf16 v[12:15], v[88:91], v[96:99], 0
    v_max3_u32 v8, v96, v97, v98
    v_max_u32 v8, v8, v99
    v_mfma_f32_16x16x32_bf16 v[12:15], v[88:91], v[100:103], v[12:15]
    v_max3_u32 v9, v100, v101, v102
    v_max_u32 v9, v9, v103
    v_mfma_f32_16x16x32_bf16 v[12:15], v[88:91], v[104:107], v[12:15]
    v_max3_u32 v10, v104, v105, v106
    v_max_u32 v10, v10, v107
    v_mfma_f32_16x16x32_bf16 v[12:15], v[88:91], v[108:111], v[12:15]
    v_max3_u32 v11, v108, v109, v110
    v_max_u32 v11, v11, v111
    v_max3_u32 v16, v8, v9, v10
    v_max_u32 v16, v16, v11
    v_cmp_eq_u32 vcc, -1, v16
    s_nop 0
    s_cbranch_vccz L_p2ok
    v_cmp_eq_u32 s[20:21], -1, v8
    v_cmp_eq_u32 s[22:23], -1, v9
    v_cmp_eq_u32 s[24:25], -1, v10
    v_cmp_eq_u32 s[26:27], -1, v11
    s_cmp_le_u32 s94, 60000
    s_cbranch_scc1 L_p2
L_p2ok:
    s_nop 0
    v_add_f32_dpp v12, v12, v12 row_ror:8 row_mask:0xf bank_mask:0xf
    v_add_f32_dpp v13, v13, v13 row_ror:8 row_mask:0xf bank_mask:0xf
    v_add_f32_dpp v14, v14, v14 row_ror:8 row_mask:0xf bank_mask:0xf
    v_add_f32_dpp v15, v15, v15 row_ror:8 row_mask:0xf bank_mask:0xf
    v_pk_add_f32 v[12:13], v[12:13], v[52:53]
    v_pk_add_f32 v[14:15], v[14:15], v[54:55]
    v_cvt_pk_bf16_f32 v12, v12, v13
    v_cvt_pk_bf16_f32 v13, v14, v15
    s_mov_b64 exec, s[88:89]
    buffer_store_dwordx2 v[12:13], v241, s[72:75], s12 offen
    s_or_b32 s90, s2, s34
    s_cbranch_scc1 L_exit
    s_mov_b64 exec, 1
    v_mov_b32 v14, s38
    buffer_store_dword v14, v232, s[52:55], 0 offen
    s_branch L_exit
L_hg:
    buffer_store_dwordx2 v[92:93], v241, s[52:55], s14 offen sc1
    s_branch L_hd
L_a1g:
    buffer_store_dword v36, v234, s[52:55], s7 offen sc1
    s_mov_b64 exec, 1
    buffer_store_dword v14, v232, s[52:55], s8 offen sc1
    s_mov_b64 exec, -1
    v_lshlrev_b32 v12, 5, v0
    s_mov_b32 s88, 4096
    s_mov_b32 s94, 0
L_tn:
    buffer_load_dwordx4 v[20:23], v12, s[52:55], s88 offen sc1
    buffer_load_dwordx4 v[24:27], v12, s[52:55], s88 offen offset:16 sc1
    s_waitcnt vmcnt(0)
    v_xor_b32 v13, s39, v21
    v_xor_b32 v14, s39, v23
    v_xor_b32 v15, s39, v25
    v_or3_b32 v13, v13, v14, v15
    v_xor_b32 v14, s39, v27
    v_or_b32 v13, v13, v14
    v_and_b32 v13, 0x0fffffff, v13
    v_xor_b32 v14, s38, v20
    v_xor_b32 v15, s38, v22
    v_or3_b32 v13, v13, v14, v15
    v_xor_b32 v14, s38, v24
    v_xor_b32 v15, s38, v26
    v_or3_b32 v13, v13, v14, v15
    v_cmp_ne_u32 vcc, 0, v13
    s_nop 0
    s_cbranch_vccz L_tnok
    s_add_u32 s94, s94, 1
    s_cmp_le_u32 s94, 60000
    s_cbranch_scc1 L_tn
L_tnok:
    s_branch L_a1d
L_qnbn:
    s_mov_b32 s94, 1
    buffer_load_dwordx4 v[36:39], v3, s[52:55], s4 offen sc1
    buffer_load_dwordx4 v[40:43], v3, s[52:55], s4 offen offset:1024 sc1
    s_branch L_qnbrn
L_qnbf:
    s_mov_b32 s94, 1
    buffer_load_dwordx4 v[36:39], v3, s[52:55], s4 offen sc1
    buffer_load_dwordx4 v[40:43], v3, s[52:55], s4 offen offset:1024 sc1
    s_branch L_qnbrn
L_qretry:
    v_mov_b32 v10, 145600
    v_mov_b32 v11, 1
    ds_write_b32 v10, v11
    s_add_u32 s94, s94, 1
    s_cmp_gt_u32 s94, 60000
    s_cbranch_scc1 L_qok
    s_add_u32 s90, s4, 524288
    s_bitcmp1_b32 s94, 0
    s_cselect_b32 s90, s4, s90
    buffer_load_dwordx4 v[36:39], v3, s[52:55], s90 offen sc1
    buffer_load_dwordx4 v[40:43], v3, s[52:55], s90 offen offset:1024 sc1
    s_waitcnt vmcnt(0)
    s_branch L_qchk
L_wretryb:
    s_cmp_gt_u32 s94, 60000
    s_cbranch_scc1 L_wokb
    buffer_load_dwordx4 v[52:55], v237, s[52:55], s10 offen sc1
    s_mov_b64 exec, s[20:21]
    s_cbranch_execz L_wgb
    buffer_load_dwordx4 v[36:39], v236, s[52:55], s9 offen offset:0 sc1
    buffer_load_dwordx4 v[40:43], v236, s[52:55], s9 offen offset:2048 sc1
    buffer_load_dwordx4 v[44:47], v236, s[52:55], s92 offen offset:0 sc1
    buffer_load_dwordx4 v[48:51], v236, s[52:55], s92 offen offset:2048 sc1
L_wgb:
    s_mov_b64 exec, -1
    s_add_u32 s94, s94, 1
    s_branch L_wchkb
L_notw:
    s_cmp_eq_u32 s36, 0
    s_cbranch_scc1 L_exit
    s_cmp_eq_u32 s36, 3
    s_cbranch_scc1 L_f2
    s_mov_b32 s62, 1835008
    s_mov_b32 s63, 0x00020000
    s_mul_i32 s5, s34, 458752
    s_lshl_b32 s91, s35, 7
    s_add_u32 s5, s5, s91
    s_add_u32 s5, s5, 0
    s_add_u32 m0, s19, 0
    v_bfe_u32 v9, v0, 4, 2
    v_lshlrev_b32 v9, 3, v9
    v_and_b32 v10, 1, v0
    v_lshl_add_u32 v16, v10, 2, v9
    s_lshl_b32 s89, s34, 5
    s_add_u32 s91, s91, s89
    buffer_load_dword v252, v16, s[76:79], s91 offen
    buffer_load_dwordx4 v233, s[60:63], s5 offen nt lds
    s_add_u32 m0, m0, 1024
    s_add_u32 s5, s5, s6
    buffer_load_dwordx4 v238, s[60:63], s5 offen nt lds
    s_add_u32 m0, m0, 1024
    s_add_u32 s5, s5, s6
    buffer_load_dwordx4 v233, s[60:63], s5 offen nt lds
    s_add_u32 m0, m0, 1024
    s_add_u32 s5, s5, s6
    buffer_load_dwordx4 v238, s[60:63], s5 offen nt lds
    s_add_u32 m0, m0, 1024
    s_add_u32 s5, s5, s6
    buffer_load_dwordx4 v233, s[60:63], s5 offen nt lds
    s_add_u32 m0, m0, 1024
    s_add_u32 s5, s5, s6
    buffer_load_dwordx4 v238, s[60:63], s5 offen nt lds
    s_add_u32 m0, m0, 1024
    s_add_u32 s5, s5, s6
    buffer_load_dwordx4 v233, s[60:63], s5 offen nt lds
    s_add_u32 m0, m0, 1024
    s_add_u32 s5, s5, s6
    buffer_load_dwordx4 v238, s[60:63], s5 offen nt lds
    s_add_u32 m0, m0, 1024
    s_add_u32 s5, s5, s6
    buffer_load_dwordx4 v233, s[60:63], s5 offen nt lds
    s_add_u32 m0, m0, 1024
    s_add_u32 s5, s5, s6
    buffer_load_dwordx4 v238, s[60:63], s5 offen nt lds
    s_add_u32 m0, m0, 1024
    s_add_u32 s5, s5, s6
    buffer_load_dwordx4 v233, s[60:63], s5 offen nt lds
    s_add_u32 m0, m0, 1024
    s_add_u32 s5, s5, s6
    buffer_load_dwordx4 v238, s[60:63], s5 offen nt lds
    s_add_u32 m0, m0, 1024
    s_add_u32 s5, s5, s6
    buffer_load_dwordx4 v233, s[60:63], s5 offen nt lds
    s_add_u32 m0, m0, 1024
    s_add_u32 s5, s5, s6
    buffer_load_dwordx4 v238, s[60:63], s5 offen nt lds
    s_add_u32 m0, m0, 1024
    s_add_u32 s5, s5, s6
    buffer_load_dwordx4 v233, s[60:63], s5 offen nt lds
    s_add_u32 m0, m0, 1024
    s_add_u32 s5, s5, s6
    buffer_load_dwordx4 v238, s[60:63], s5 offen nt lds
    s_lshl_b32 s90, s34, 8
    s_lshl_b32 s17, s30, 13
    s_add_u32 s17, s17, 65536
    s_add_u32 s17, s17, s90
    s_lshl_b32 s18, s35, 10
    s_add_u32 s18, s18, s90
    s_add_u32 s18, s18, 131072
    v_lshrrev_b32 v13, 3, v2
    v_and_b32 v14, 7, v2
    s_lshl_b32 s90, s34, 14
    s_add_u32 s90, s90, 65536
    v_lshlrev_b32 v8, 7, v1
    v_lshl_add_u32 v8, v14, 4, v8
    v_lshl_add_u32 v8, v13, 10, v8
    v_add_u32 v244, s90, v8
    s_lshl_b32 s90, s34, 9
    s_add_u32 s90, s90, 65536
    v_lshl_add_u32 v245, v0, 3, s90
    s_lshl_b32 s90, s34, 2
    s_add_u32 s90, s90, 145664
    v_lshl_add_u32 v246, v14, 5, s90
    v_bfe_u32 v8, v0, 1, 3
    v_lshlrev_b32 v9, 5, v8
    v_add_u32 v247, 145664, v9
    v_lshrrev_b32 v9, 5, v0
    v_lshlrev_b32 v9, 7, v9
    v_lshl_add_u32 v9, v8, 4, v9
    v_and_b32 v8, 1, v1
    v_lshl_add_u32 v9, v8, 3, v9
    v_lshl_add_u32 v248, v10, 2, v9
    v_cmp_eq_u32 vcc, 0, v13
    v_mov_b32 v10, s43
    s_nop 0
    v_cndmask_b32 v4, 0, v10, vcc
    v_xor_b32 v84, v10, v4
    v_lshlrev_b32 v8, 10, v14
    v_lshl_add_u32 v8, v13, 6, v8
    v_lshl_add_u32 v251, v1, 4, v8
    v_mov_b32 v5, v4
    v_mov_b32 v6, v4
    v_mov_b32 v7, v4
    v_mov_b32 v85, v84
    v_mov_b32 v86, v84
    v_mov_b32 v87, v84
    v_xor_b32 v8, 64, v235
    v_xor_b32 v9, 64, v239
    s_waitcnt vmcnt(12)
    v_and_b32 v253, 0xffff0000, v252
    v_lshlrev_b32 v252, 16, v252
    ds_read_b64_tr_b16 v[96:97], v235 offset:0
    ds_read_b64_tr_b16 v[98:99], v235 offset:512
    ds_read_b64_tr_b16 v[100:101], v239 offset:0
    ds_read_b64_tr_b16 v[102:103], v239 offset:512
    ds_read_b64_tr_b16 v[104:105], v8 offset:0
    ds_read_b64_tr_b16 v[106:107], v8 offset:512
    ds_read_b64_tr_b16 v[108:109], v9 offset:0
    ds_read_b64_tr_b16 v[110:111], v9 offset:512
    s_waitcnt lgkmcnt(0)
    v_mfma_f32_16x16x32_bf16 v[20:23], v[96:99], v[4:7], 0
    v_mfma_f32_16x16x32_bf16 v[24:27], v[100:103], v[4:7], 0
    v_mfma_f32_16x16x32_bf16 v[20:23], v[104:107], v[84:87], v[20:23]
    v_mfma_f32_16x16x32_bf16 v[24:27], v[108:111], v[84:87], v[24:27]
    s_waitcnt vmcnt(8)
    ds_read_b64_tr_b16 v[112:113], v235 offset:4096
    ds_read_b64_tr_b16 v[114:115], v235 offset:4608
    ds_read_b64_tr_b16 v[116:117], v239 offset:4096
    ds_read_b64_tr_b16 v[118:119], v239 offset:4608
    ds_read_b64_tr_b16 v[120:121], v8 offset:4096
    ds_read_b64_tr_b16 v[122:123], v8 offset:4608
    ds_read_b64_tr_b16 v[124:125], v9 offset:4096
    ds_read_b64_tr_b16 v[126:127], v9 offset:4608
    s_waitcnt lgkmcnt(0)
    v_mfma_f32_16x16x32_bf16 v[20:23], v[112:115], v[4:7], v[20:23]
    v_mfma_f32_16x16x32_bf16 v[24:27], v[116:119], v[4:7], v[24:27]
    v_mfma_f32_16x16x32_bf16 v[20:23], v[120:123], v[84:87], v[20:23]
    v_mfma_f32_16x16x32_bf16 v[24:27], v[124:127], v[84:87], v[24:27]
    s_waitcnt vmcnt(4)
    ds_read_b64_tr_b16 v[192:193], v235 offset:8192
    ds_read_b64_tr_b16 v[194:195], v235 offset:8704
    ds_read_b64_tr_b16 v[196:197], v239 offset:8192
    ds_read_b64_tr_b16 v[198:199], v239 offset:8704
    ds_read_b64_tr_b16 v[200:201], v8 offset:8192
    ds_read_b64_tr_b16 v[202:203], v8 offset:8704
    ds_read_b64_tr_b16 v[204:205], v9 offset:8192
    ds_read_b64_tr_b16 v[206:207], v9 offset:8704
    s_waitcnt lgkmcnt(0)
    v_mfma_f32_16x16x32_bf16 v[20:23], v[192:195], v[4:7], v[20:23]
    v_mfma_f32_16x16x32_bf16 v[24:27], v[196:199], v[4:7], v[24:27]
    v_mfma_f32_16x16x32_bf16 v[20:23], v[200:203], v[84:87], v[20:23]
    v_mfma_f32_16x16x32_bf16 v[24:27], v[204:207], v[84:87], v[24:27]
    s_waitcnt vmcnt(0)
    ds_read_b64_tr_b16 v[208:209], v235 offset:12288
    ds_read_b64_tr_b16 v[210:211], v235 offset:12800
    ds_read_b64_tr_b16 v[212:213], v239 offset:12288
    ds_read_b64_tr_b16 v[214:215], v239 offset:12800
    ds_read_b64_tr_b16 v[216:217], v8 offset:12288
    ds_read_b64_tr_b16 v[218:219], v8 offset:12800
    ds_read_b64_tr_b16 v[220:221], v9 offset:12288
    ds_read_b64_tr_b16 v[222:223], v9 offset:12800
    s_waitcnt lgkmcnt(0)
    v_mfma_f32_16x16x32_bf16 v[20:23], v[208:211], v[4:7], v[20:23]
    v_mfma_f32_16x16x32_bf16 v[24:27], v[212:215], v[4:7], v[24:27]
    v_mfma_f32_16x16x32_bf16 v[20:23], v[216:219], v[84:87], v[20:23]
    v_mfma_f32_16x16x32_bf16 v[24:27], v[220:223], v[84:87], v[24:27]
    s_nop 6
    ds_write_b128 v244, v[20:23] offset:2048
    ds_write_b128 v244, v[24:27] offset:2560
    s_waitcnt lgkmcnt(0)
    s_barrier
    ds_read_b64 v[84:85], v245 offset:2048
    ds_read_b64 v[86:87], v245 offset:18432
    ds_read_b64 v[88:89], v245 offset:34816
    ds_read_b64 v[90:91], v245 offset:51200
    s_waitcnt lgkmcnt(0)
    v_pk_add_f32 v[84:85], v[84:85], v[86:87]
    v_pk_add_f32 v[88:89], v[88:89], v[90:91]
    v_pk_add_f32 v[254:255], v[84:85], v[88:89]
    s_mov_b32 s94, 0
L_h:
    buffer_load_dwordx4 v[128:131], v251, s[52:55], s17 offen sc1
    buffer_load_dwordx4 v[132:135], v251, s[52:55], s17 offen offset:128 sc1
    s_waitcnt vmcnt(0)
    v_mfma_f32_16x16x32_bf16 v[136:139], v[96:99], v[128:131], 0
    v_max3_u32 v8, v128, v129, v130
    v_max3_u32 v8, v8, v131, v132
    v_mfma_f32_16x16x32_bf16 v[152:155], v[112:115], v[128:131], 0
    v_max3_u32 v8, v8, v133, v134
    v_max_u32 v8, v8, v135
    v_cmp_eq_u32 vcc, -1, v8
    s_nop 0
    s_cbranch_vccz L_hok
    s_add_u32 s94, s94, 1
    s_cmp_le_u32 s94, 60000
    s_cbranch_scc1 L_h
L_hok:
    v_dot2_f32_bf16 v12, v128, s43, 0
    v_dot2_f32_bf16 v13, v128, v128, 0
    v_dot2_f32_bf16 v12, v129, s43, v12
    v_dot2_f32_bf16 v13, v129, v129, v13
    v_dot2_f32_bf16 v12, v130, s43, v12
    v_dot2_f32_bf16 v13, v130, v130, v13
    v_dot2_f32_bf16 v12, v131, s43, v12
    v_dot2_f32_bf16 v13, v131, v131, v13
    v_dot2_f32_bf16 v12, v132, s43, v12
    v_dot2_f32_bf16 v13, v132, v132, v13
    v_dot2_f32_bf16 v12, v133, s43, v12
    v_dot2_f32_bf16 v13, v133, v133, v13
    v_dot2_f32_bf16 v12, v134, s43, v12
    v_dot2_f32_bf16 v13, v134, v134, v13
    v_dot2_f32_bf16 v12, v135, s43, v12
    v_dot2_f32_bf16 v13, v135, v135, v13
    v_mfma_f32_16x16x32_bf16 v[144:147], v[104:107], v[128:131], 0
    v_mfma_f32_16x16x32_bf16 v[160:163], v[120:123], v[128:131], 0
    v_mfma_f32_16x16x32_bf16 v[140:143], v[100:103], v[128:131], 0
    v_mov_b32 v14, v12
    v_mov_b32 v15, v13
    v_mfma_f32_16x16x32_bf16 v[156:159], v[116:119], v[128:131], 0
    v_mfma_f32_16x16x32_bf16 v[148:151], v[108:111], v[128:131], 0
    v_permlane16_swap_b32 v12, v14
    v_mfma_f32_16x16x32_bf16 v[164:167], v[124:127], v[128:131], 0
    v_permlane16_swap_b32 v13, v15
    v_mfma_f32_16x16x32_bf16 v[136:139], v[192:195], v[132:135], v[136:139]
    v_add_f32 v12, v12, v14
    v_add_f32 v13, v13, v15
    v_mfma_f32_16x16x32_bf16 v[152:155], v[208:211], v[132:135], v[152:155]
    v_mov_b32 v14, v12
    v_mov_b32 v15, v13
    v_mfma_f32_16x16x32_bf16 v[144:147], v[200:203], v[132:135], v[144:147]
    v_mfma_f32_16x16x32_bf16 v[160:163], v[216:219], v[132:135], v[160:163]
    v_permlane32_swap_b32 v12, v14
    v_mfma_f32_16x16x32_bf16 v[140:143], v[196:199], v[132:135], v[140:143]
    v_permlane32_swap_b32 v13, v15
    v_mfma_f32_16x16x32_bf16 v[156:159], v[212:215], v[132:135], v[156:159]
    v_add_f32 v12, v12, v14
    v_add_f32 v13, v13, v15
    v_mfma_f32_16x16x32_bf16 v[148:151], v[204:207], v[132:135], v[148:151]
    v_mfma_f32_16x16x32_bf16 v[164:167], v[220:223], v[132:135], v[164:167]
    v_add_f32_dpp v12, v12, v12 row_ror:8 row_mask:0xf bank_mask:0xf
    v_add_f32_dpp v13, v13, v13 row_ror:8 row_mask:0xf bank_mask:0xf
    ds_write2_b32 v246, v12, v13 offset0:0 offset1:4
    v_add_f32_dpp v136, v152, v136 row_ror:8 row_mask:0xf bank_mask:0x3
    v_add_f32_dpp v137, v153, v137 row_ror:8 row_mask:0xf bank_mask:0x3
    v_add_f32_dpp v138, v154, v138 row_ror:8 row_mask:0xf bank_mask:0x3
    v_add_f32_dpp v139, v155, v139 row_ror:8 row_mask:0xf bank_mask:0x3
    v_add_f32_dpp v136, v144, v160 row_ror:8 row_mask:0xf bank_mask:0xc
    v_add_f32_dpp v137, v145, v161 row_ror:8 row_mask:0xf bank_mask:0xc
    v_add_f32_dpp v138, v146, v162 row_ror:8 row_mask:0xf bank_mask:0xc
    v_add_f32_dpp v139, v147, v163 row_ror:8 row_mask:0xf bank_mask:0xc
    ds_write_b128 v244, v[136:139] offset:0
    v_add_f32_dpp v140, v156, v140 row_ror:8 row_mask:0xf bank_mask:0x3
    v_add_f32_dpp v141, v157, v141 row_ror:8 row_mask:0xf bank_mask:0x3
    v_add_f32_dpp v142, v158, v142 row_ror:8 row_mask:0xf bank_mask:0x3
    v_add_f32_dpp v143, v159, v143 row_ror:8 row_mask:0xf bank_mask:0x3
    v_add_f32_dpp v140, v148, v164 row_ror:8 row_mask:0xf bank_mask:0xc
    v_add_f32_dpp v141, v149, v165 row_ror:8 row_mask:0xf bank_mask:0xc
    v_add_f32_dpp v142, v150, v166 row_ror:8 row_mask:0xf bank_mask:0xc
    v_add_f32_dpp v143, v151, v167 row_ror:8 row_mask:0xf bank_mask:0xc
    ds_write_b128 v244, v[140:143] offset:512
    s_waitcnt vmcnt(0) lgkmcnt(0)
    s_barrier
    ds_read_b128 v[8:11], v247
    ds_read_b128 v[12:15], v247 offset:16
    ds_read_b64 v[128:129], v245 offset:0
    ds_read_b64 v[130:131], v245 offset:16384
    ds_read_b64 v[132:133], v245 offset:32768
    ds_read_b64 v[134:135], v245 offset:49152
    v_mov_b32 v4, 0xc0135761
    v_mov_b32 v5, 0xc0135761
    v_mov_b32 v6, 0x3727c5ac
    s_waitcnt lgkmcnt(4)
    v_pk_add_f32 v[8:9], v[8:9], v[10:11]
    v_pk_add_f32 v[12:13], v[12:13], v[14:15]
    v_add_f32 v8, v8, v9
    v_add_f32 v12, v12, v13
    v_mul_f32 v8, 0x3b000000, v8
    v_fmac_f32 v6, 0x3b000000, v12
    v_fma_f32 v6, -v8, v8, v6
    v_max_f32 v6, 0x3727c5ac, v6
    v_rsq_f32 v6, v6
    s_cmp_eq_u32 s37, 0
    s_waitcnt lgkmcnt(0)
    v_pk_add_f32 v[128:129], v[128:129], v[130:131]
    v_pk_add_f32 v[132:133], v[132:133], v[134:135]
    v_pk_add_f32 v[128:129], v[128:129], v[132:133]
    v_fma_f32 v128, -v8, v254, v128
    v_fma_f32 v129, -v8, v255, v129
    v_fma_f32 v12, v128, v6, v252
    v_fma_f32 v13, v129, v6, v253
    v_pk_mul_f32 v[14:15], v[12:13], v[12:13]
    v_fmac_f32 v4, 0xbdd2d3e8, v14
    v_fmac_f32 v5, 0xbdd2d3e8, v15
    v_pk_mul_f32 v[14:15], v[12:13], v[4:5]
    v_exp_f32 v14, v14
    v_exp_f32 v15, v15
    v_add_f32 v14, 1.0, v14
    v_add_f32 v15, 1.0, v15
    v_rcp_f32 v14, v14
    v_rcp_f32 v15, v15
    s_nop 0
    v_pk_mul_f32 v[12:13], v[12:13], v[14:15]
    v_cvt_pk_bf16_f32 v12, v12, v13
    s_cbranch_scc1 L_gg
    buffer_store_dword v12, v248, s[52:55], s18 offen
    s_branch L_exit
L_gg:
    buffer_store_dword v12, v248, s[52:55], s18 offen sc1
    s_branch L_exit
L_f2:
    s_mov_b32 s66, 1835008
    s_mov_b32 s67, 0x00020000
    v_and_b32 v8, 1, v1
    v_lshrrev_b32 v9, 1, v1
    v_lshl_or_b32 v8, v9, 3, v8
    v_xor_b32 v8, v8, v2
    v_lshlrev_b32 v8, 4, v8
    v_lshl_add_u32 v8, v1, 10, v8
    s_lshl_b32 s90, s34, 8
    s_lshl_b32 s5, s35, 16
    s_add_u32 s5, s5, s90
    s_lshl_b32 m0, s34, 14
    v_lshlrev_b32 v9, 3, v0
    s_lshl_b32 s90, s30, 9
    s_add_u32 s90, s90, 8192
    s_mov_b32 s94, 0
L_f2w:
    buffer_load_dwordx2 v[10:11], v9, s[52:55], s90 offen sc1
    s_waitcnt vmcnt(0)
    v_max_u32 v10, v10, v11
    v_cmp_eq_u32 vcc, -1, v10
    s_nop 0
    s_cbranch_vccz L_f2k
    s_add_u32 s94, s94, 1
    s_cmp_le_u32 s94, 60000
    s_cbranch_scc1 L_f2w
L_f2k:
    buffer_load_dwordx4 v8, s[64:67], s5 offen nt lds
    s_add_u32 m0, m0, 1024
    s_add_u32 s5, s5, 4096
    buffer_load_dwordx4 v8, s[64:67], s5 offen nt lds
    s_add_u32 m0, m0, 1024
    s_add_u32 s5, s5, 4096
    buffer_load_dwordx4 v8, s[64:67], s5 offen nt lds
    s_add_u32 m0, m0, 1024
    s_add_u32 s5, s5, 4096
    buffer_load_dwordx4 v8, s[64:67], s5 offen nt lds
    s_add_u32 m0, m0, 1024
    s_add_u32 s5, s5, 4096
    buffer_load_dwordx4 v8, s[64:67], s5 offen nt lds
    s_add_u32 m0, m0, 1024
    s_add_u32 s5, s5, 4096
    buffer_load_dwordx4 v8, s[64:67], s5 offen nt lds
    s_add_u32 m0, m0, 1024
    s_add_u32 s5, s5, 4096
    buffer_load_dwordx4 v8, s[64:67], s5 offen nt lds
    s_add_u32 m0, m0, 1024
    s_add_u32 s5, s5, 4096
    buffer_load_dwordx4 v8, s[64:67], s5 offen nt lds
    s_add_u32 m0, m0, 1024
    s_add_u32 s5, s5, 4096
    buffer_load_dwordx4 v8, s[64:67], s5 offen nt lds
    s_add_u32 m0, m0, 1024
    s_add_u32 s5, s5, 4096
    buffer_load_dwordx4 v8, s[64:67], s5 offen nt lds
    s_add_u32 m0, m0, 1024
    s_add_u32 s5, s5, 4096
    buffer_load_dwordx4 v8, s[64:67], s5 offen nt lds
    s_add_u32 m0, m0, 1024
    s_add_u32 s5, s5, 4096
    buffer_load_dwordx4 v8, s[64:67], s5 offen nt lds
    s_add_u32 m0, m0, 1024
    s_add_u32 s5, s5, 4096
    buffer_load_dwordx4 v8, s[64:67], s5 offen nt lds
    s_add_u32 m0, m0, 1024
    s_add_u32 s5, s5, 4096
    buffer_load_dwordx4 v8, s[64:67], s5 offen nt lds
    s_add_u32 m0, m0, 1024
    s_add_u32 s5, s5, 4096
    buffer_load_dwordx4 v8, s[64:67], s5 offen nt lds
    s_add_u32 m0, m0, 1024
    s_add_u32 s5, s5, 4096
    buffer_load_dwordx4 v8, s[64:67], s5 offen nt lds
    s_lshl_b32 s18, s35, 7
    s_lshl_b32 s90, s34, 14
    s_add_u32 s18, s18, s90
    s_add_u32 s18, s18, 1048576
    s_add_u32 s18, s18, s99
    s_add_u32 s4, s18, 4096
    s_lshl_b32 s17, s35, 10
    s_add_u32 s17, s17, 131072
    v_lshrrev_b32 v13, 3, v2
    v_and_b32 v14, 7, v2
    v_lshlrev_b32 v8, 16, v14
    v_lshl_add_u32 v8, v1, 5, v8
    v_lshl_add_u32 v250, v13, 4, v8
    v_lshlrev_b32 v8, 4, v14
    v_lshl_add_u32 v8, v13, 9, v8
    v_lshl_add_u32 v251, v1, 7, v8
    s_lshl_b32 s88, s30, 1
    s_lshl_b32 s88, 0x03030303, s88
    s_cmp_lg_u32 s37, 0
    s_cselect_b32 s22, s88, 0
    s_mov_b32 s23, s22
    s_not_b64 s[20:21], s[22:23]
    s_mov_b32 s24, 0x00ff00ff
    s_mov_b32 s25, 0x00ff00ff
    s_not_b64 s[26:27], s[24:25]
    v_lshrrev_b32 v12, 2, v2
    v_and_b32 v13, 1, v12
    v_lshrrev_b32 v14, 1, v12
    v_lshl_or_b32 v13, v14, 3, v13
    v_and_b32 v14, 3, v0
    v_lshlrev_b32 v14, 1, v14
    v_xor_b32 v13, v13, v14
    v_lshlrev_b32 v13, 4, v13
    v_lshl_add_u32 v12, v1, 3, v12
    v_lshl_add_u32 v12, v12, 8, v13
    s_lshl_b32 s90, s34, 14
    v_add_u32 v12, s90, v12
    v_xor_b32 v13, 16, v12
    v_xor_b32 v14, 0x80, v12
    v_xor_b32 v15, 0x90, v12
    s_waitcnt vmcnt(8)
    ds_read_b64_tr_b16 v[20:21], v12 offset:0
    ds_read_b64_tr_b16 v[22:23], v12 offset:1024
    ds_read_b64_tr_b16 v[24:25], v13 offset:0
    ds_read_b64_tr_b16 v[26:27], v13 offset:1024
    ds_read_b64_tr_b16 v[28:29], v14 offset:0
    ds_read_b64_tr_b16 v[30:31], v14 offset:1024
    ds_read_b64_tr_b16 v[32:33], v15 offset:0
    ds_read_b64_tr_b16 v[34:35], v15 offset:1024
    s_waitcnt lgkmcnt(8)
    ds_read_b64_tr_b16 v[36:37], v12 offset:8
    ds_read_b64_tr_b16 v[38:39], v12 offset:1032
    ds_read_b64_tr_b16 v[40:41], v13 offset:8
    ds_read_b64_tr_b16 v[42:43], v13 offset:1032
    ds_read_b64_tr_b16 v[44:45], v14 offset:8
    ds_read_b64_tr_b16 v[46:47], v14 offset:1032
    ds_read_b64_tr_b16 v[48:49], v15 offset:8
    ds_read_b64_tr_b16 v[50:51], v15 offset:1032
    s_waitcnt lgkmcnt(8)
    s_waitcnt vmcnt(0)
    ds_read_b64_tr_b16 v[52:53], v12 offset:8192
    ds_read_b64_tr_b16 v[54:55], v12 offset:9216
    ds_read_b64_tr_b16 v[56:57], v13 offset:8192
    ds_read_b64_tr_b16 v[58:59], v13 offset:9216
    ds_read_b64_tr_b16 v[60:61], v14 offset:8192
    ds_read_b64_tr_b16 v[62:63], v14 offset:9216
    ds_read_b64_tr_b16 v[64:65], v15 offset:8192
    ds_read_b64_tr_b16 v[66:67], v15 offset:9216
    s_waitcnt lgkmcnt(8)
    ds_read_b64_tr_b16 v[68:69], v12 offset:8200
    ds_read_b64_tr_b16 v[70:71], v12 offset:9224
    ds_read_b64_tr_b16 v[72:73], v13 offset:8200
    ds_read_b64_tr_b16 v[74:75], v13 offset:9224
    ds_read_b64_tr_b16 v[76:77], v14 offset:8200
    ds_read_b64_tr_b16 v[78:79], v14 offset:9224
    ds_read_b64_tr_b16 v[80:81], v15 offset:8200
    ds_read_b64_tr_b16 v[82:83], v15 offset:9224
    s_waitcnt lgkmcnt(8)
    v_mov_b32 v176, 0
    v_mov_b32 v177, 0
    v_mov_b32 v178, 0
    v_mov_b32 v179, 0
    v_mov_b32 v180, 0
    v_mov_b32 v181, 0
    v_mov_b32 v182, 0
    v_mov_b32 v183, 0
    v_mov_b32 v184, 0
    v_mov_b32 v185, 0
    v_mov_b32 v186, 0
    v_mov_b32 v187, 0
    v_mov_b32 v188, 0
    v_mov_b32 v189, 0
    v_mov_b32 v190, 0
    v_mov_b32 v191, 0
    s_mov_b32 s94, 0
    s_waitcnt lgkmcnt(0)
L_g:
    buffer_load_dwordx4 v[128:131], v251, s[52:55], s17 offen sc1
    s_waitcnt vmcnt(0)
    v_mov_b32_dpp v176, v128 quad_perm:[0,1,2,3] row_mask:0xf bank_mask:0x3
    v_mov_b32_dpp v177, v129 quad_perm:[0,1,2,3] row_mask:0xf bank_mask:0x3
    v_mov_b32_dpp v178, v130 quad_perm:[0,1,2,3] row_mask:0xf bank_mask:0x3
    v_mov_b32_dpp v179, v131 quad_perm:[0,1,2,3] row_mask:0xf bank_mask:0x3
    v_max3_u32 v8, v128, v129, v130
    v_max_u32 v8, v8, v131
    v_mfma_f32_16x16x32_bf16 v[136:139], v[20:23], v[176:179], 0
    v_cmp_eq_u32 vcc, -1, v8
    s_nop 0
    s_cbranch_vccz L_gok
    s_add_u32 s94, s94, 1
    s_cmp_le_u32 s94, 60000
    s_cbranch_scc1 L_g
L_gok:
    v_mfma_f32_16x16x32_bf16 v[140:143], v[24:27], v[176:179], 0
    v_mov_b32_dpp v180, v128 row_ror:8 row_mask:0xf bank_mask:0xc
    v_mov_b32_dpp v181, v129 row_ror:8 row_mask:0xf bank_mask:0xc
    v_mfma_f32_16x16x32_bf16 v[144:147], v[28:31], v[176:179], 0
    v_mov_b32_dpp v182, v130 row_ror:8 row_mask:0xf bank_mask:0xc
    v_mov_b32_dpp v183, v131 row_ror:8 row_mask:0xf bank_mask:0xc
    v_mfma_f32_16x16x32_bf16 v[148:151], v[32:35], v[176:179], 0
    v_mov_b32_dpp v184, v128 row_ror:8 row_mask:0xf bank_mask:0x3
    v_mov_b32_dpp v185, v129 row_ror:8 row_mask:0xf bank_mask:0x3
    v_mfma_f32_16x16x32_bf16 v[136:139], v[36:39], v[180:183], v[136:139]
    v_mov_b32_dpp v186, v130 row_ror:8 row_mask:0xf bank_mask:0x3
    v_mov_b32_dpp v187, v131 row_ror:8 row_mask:0xf bank_mask:0x3
    v_mfma_f32_16x16x32_bf16 v[140:143], v[40:43], v[180:183], v[140:143]
    v_mov_b32_dpp v188, v128 quad_perm:[0,1,2,3] row_mask:0xf bank_mask:0xc
    v_mov_b32_dpp v189, v129 quad_perm:[0,1,2,3] row_mask:0xf bank_mask:0xc
    v_mfma_f32_16x16x32_bf16 v[144:147], v[44:47], v[180:183], v[144:147]
    v_mov_b32_dpp v190, v130 quad_perm:[0,1,2,3] row_mask:0xf bank_mask:0xc
    v_mov_b32_dpp v191, v131 quad_perm:[0,1,2,3] row_mask:0xf bank_mask:0xc
    v_mfma_f32_16x16x32_bf16 v[148:151], v[48:51], v[180:183], v[148:151]
    v_mfma_f32_16x16x32_bf16 v[136:139], v[52:55], v[184:187], v[136:139]
    v_mfma_f32_16x16x32_bf16 v[140:143], v[56:59], v[184:187], v[140:143]
    v_mfma_f32_16x16x32_bf16 v[144:147], v[60:63], v[184:187], v[144:147]
    v_mfma_f32_16x16x32_bf16 v[148:151], v[64:67], v[184:187], v[148:151]
    v_mfma_f32_16x16x32_bf16 v[136:139], v[68:71], v[188:191], v[136:139]
    v_mfma_f32_16x16x32_bf16 v[140:143], v[72:75], v[188:191], v[140:143]
    v_mfma_f32_16x16x32_bf16 v[144:147], v[76:79], v[188:191], v[144:147]
    v_mfma_f32_16x16x32_bf16 v[148:151], v[80:83], v[188:191], v[148:151]
    s_nop 4
    v_cvt_pk_bf16_f32 v168, v136, v137
    v_cvt_pk_bf16_f32 v169, v138, v139
    v_cvt_pk_bf16_f32 v170, v140, v141
    v_cvt_pk_bf16_f32 v171, v142, v143
    v_cvt_pk_bf16_f32 v172, v144, v145
    v_cvt_pk_bf16_f32 v173, v146, v147
    v_cvt_pk_bf16_f32 v174, v148, v149
    v_cvt_pk_bf16_f32 v175, v150, v151
    s_mov_b64 exec, s[20:21]
    buffer_store_dwordx4 v[168:171], v250, s[52:55], s18 offen sc1
    buffer_store_dwordx4 v[172:175], v250, s[52:55], s4 offen sc1
    s_mov_b64 exec, s[22:23]
    s_cbranch_execz L_p2d
    buffer_store_dwordx4 v[168:171], v250, s[52:55], s18 offen
    buffer_store_dwordx4 v[172:175], v250, s[52:55], s4 offen
L_p2d:
    s_mov_b64 exec, -1
    s_branch L_exit
L_qrest:
    s_mov_b32 s40, 0x05040100
    s_mov_b32 s41, 0x07060302
    s_mov_b32 s43, 0x3f803f80
    s_lshl_b32 s5, s30, 16
    s_lshl_b32 s6, s31, 8
    s_add_u32 s5, s5, s6
    s_add_u32 s5, s5, 3145728
    s_lshl_b32 s4, s4, 3
    s_add_u32 s4, s4, 4096
    s_waitcnt lgkmcnt(0)
    s_getreg_b32 s91, hwreg(HW_REG_XCC_ID)
    s_add_u32 s38, s38, 1
    s_and_b32 s39, s39, 0x0fffffff
    s_lshl_b32 s91, s91, 28
    s_or_b32 s39, s39, s91
    v_mov_b32 v10, s38
    v_mov_b32 v11, s39
    v_mov_b32 v14, s38
    v_mov_b32 v15, s39
    s_waitcnt vmcnt(19)
    v_dot2_f32_bf16 v226, v32, s43, 0
    v_dot2_f32_bf16 v227, v32, v32, 0
    v_dot2_f32_bf16 v226, v33, s43, v226
    v_dot2_f32_bf16 v227, v33, v33, v227
    v_dot2_f32_bf16 v226, v34, s43, v226
    v_dot2_f32_bf16 v227, v34, v34, v227
    v_dot2_f32_bf16 v226, v35, s43, v226
    v_dot2_f32_bf16 v227, v35, v35, v227
    v_dot2_f32_bf16 v226, v36, s43, v226
    v_dot2_f32_bf16 v227, v36, v36, v227
    v_dot2_f32_bf16 v226, v37, s43, v226
    v_dot2_f32_bf16 v227, v37, v37, v227
    v_dot2_f32_bf16 v226, v38, s43, v226
    v_dot2_f32_bf16 v227, v38, v38, v227
    v_dot2_f32_bf16 v226, v39, s43, v226
    v_dot2_f32_bf16 v227, v39, v39, v227
    v_dot2_f32_bf16 v226, v40, s43, v226
    v_dot2_f32_bf16 v227, v40, v40, v227
    v_dot2_f32_bf16 v226, v41, s43, v226
    v_dot2_f32_bf16 v227, v41, v41, v227
    v_dot2_f32_bf16 v226, v42, s43, v226
    v_dot2_f32_bf16 v227, v42, v42, v227
    v_dot2_f32_bf16 v226, v43, s43, v226
    v_dot2_f32_bf16 v227, v43, v43, v227
    v_dot2_f32_bf16 v226, v44, s43, v226
    v_dot2_f32_bf16 v227, v44, v44, v227
    v_dot2_f32_bf16 v226, v45, s43, v226
    v_dot2_f32_bf16 v227, v45, v45, v227
    v_dot2_f32_bf16 v226, v46, s43, v226
    v_dot2_f32_bf16 v227, v46, v46, v227
    v_dot2_f32_bf16 v226, v47, s43, v226
    v_dot2_f32_bf16 v227, v47, v47, v227
    v_dot2_f32_bf16 v226, v48, s43, v226
    v_dot2_f32_bf16 v227, v48, v48, v227
    v_dot2_f32_bf16 v226, v49, s43, v226
    v_dot2_f32_bf16 v227, v49, v49, v227
    v_dot2_f32_bf16 v226, v50, s43, v226
    v_dot2_f32_bf16 v227, v50, v50, v227
    v_dot2_f32_bf16 v226, v51, s43, v226
    v_dot2_f32_bf16 v227, v51, v51, v227
    v_dot2_f32_bf16 v226, v52, s43, v226
    v_dot2_f32_bf16 v227, v52, v52, v227
    v_dot2_f32_bf16 v226, v53, s43, v226
    v_dot2_f32_bf16 v227, v53, v53, v227
    v_dot2_f32_bf16 v226, v54, s43, v226
    v_dot2_f32_bf16 v227, v54, v54, v227
    v_dot2_f32_bf16 v226, v55, s43, v226
    v_dot2_f32_bf16 v227, v55, v55, v227
    v_dot2_f32_bf16 v226, v56, s43, v226
    v_dot2_f32_bf16 v227, v56, v56, v227
    v_dot2_f32_bf16 v226, v57, s43, v226
    v_dot2_f32_bf16 v227, v57, v57, v227
    v_dot2_f32_bf16 v226, v58, s43, v226
    v_dot2_f32_bf16 v227, v58, v58, v227
    v_dot2_f32_bf16 v226, v59, s43, v226
    v_dot2_f32_bf16 v227, v59, v59, v227
    v_dot2_f32_bf16 v226, v60, s43, v226
    v_dot2_f32_bf16 v227, v60, v60, v227
    v_dot2_f32_bf16 v226, v61, s43, v226
    v_dot2_f32_bf16 v227, v61, v61, v227
    v_dot2_f32_bf16 v226, v62, s43, v226
    v_dot2_f32_bf16 v227, v62, v62, v227
    v_dot2_f32_bf16 v226, v63, s43, v226
    v_dot2_f32_bf16 v227, v63, v63, v227
    s_nop 1
    v_mov_b32 v228, v226
    v_mov_b32 v229, v227
    s_nop 0
    v_permlane16_swap_b32 v226, v228
    v_permlane16_swap_b32 v227, v229
    v_pk_add_f32 v[226:227], v[226:227], v[228:229]
    v_mov_b32 v228, v226
    v_mov_b32 v229, v227
    s_nop 0
    v_permlane32_swap_b32 v226, v228
    v_permlane32_swap_b32 v227, v229
    v_pk_add_f32 v[226:227], v[226:227], v[228:229]
    s_nop 1
    v_add_f32_dpp v226, v226, v226 row_ror:8 row_mask:0xf bank_mask:0xf
    v_add_f32_dpp v227, v227, v227 row_ror:8 row_mask:0xf bank_mask:0xf
    v_mul_f32 v228, 0x3b000000, v226
    v_mul_f32 v227, 0x3b000000, v227
    v_fma_f32 v227, -v228, v228, v227
    v_max_f32 v227, 0, v227
    v_cvt_pk_bf16_f32 v228, v228, v228
    v_lshlrev_b32 v228, 16, v228
    v_cvt_pk_bf16_f32 v227, v227, v227
    v_lshlrev_b32 v227, 16, v227
    v_add_f32 v227, 0x3727c5ac, v227
    v_cvt_pk_bf16_f32 v227, v227, v227
    v_lshlrev_b32 v227, 16, v227
    v_sqrt_f32 v227, v227
    s_nop 0
    v_cvt_pk_bf16_f32 v227, v227, v227
    v_lshlrev_b32 v227, 16, v227
    v_rcp_f32 v229, v227
    s_nop 0
    v_mul_f32 v228, v228, v229
    v_lshlrev_b32 v230, 16, v24
    v_and_b32 v231, 0xffff0000, v24
    v_fma_f32 v230, v230, v229, -v228
    v_fma_f32 v231, v231, v229, -v228
    v_cvt_pk_bf16_f32 v32, v230, v231
    v_lshlrev_b32 v230, 16, v25
    v_and_b32 v231, 0xffff0000, v25
    v_fma_f32 v230, v230, v229, -v228
    v_fma_f32 v231, v231, v229, -v228
    v_cvt_pk_bf16_f32 v33, v230, v231
    v_lshlrev_b32 v230, 16, v26
    v_and_b32 v231, 0xffff0000, v26
    v_fma_f32 v230, v230, v229, -v228
    v_fma_f32 v231, v231, v229, -v228
    v_cvt_pk_bf16_f32 v34, v230, v231
    v_lshlrev_b32 v230, 16, v27
    v_and_b32 v231, 0xffff0000, v27
    v_fma_f32 v230, v230, v229, -v228
    v_fma_f32 v231, v231, v229, -v228
    v_cvt_pk_bf16_f32 v35, v230, v231
    v_lshlrev_b32 v230, 16, v28
    v_and_b32 v231, 0xffff0000, v28
    v_fma_f32 v230, v230, v229, -v228
    v_fma_f32 v231, v231, v229, -v228
    v_cvt_pk_bf16_f32 v36, v230, v231
    v_lshlrev_b32 v230, 16, v29
    v_and_b32 v231, 0xffff0000, v29
    v_fma_f32 v230, v230, v229, -v228
    v_fma_f32 v231, v231, v229, -v228
    v_cvt_pk_bf16_f32 v37, v230, v231
    v_lshlrev_b32 v230, 16, v30
    v_and_b32 v231, 0xffff0000, v30
    v_fma_f32 v230, v230, v229, -v228
    v_fma_f32 v231, v231, v229, -v228
    v_cvt_pk_bf16_f32 v38, v230, v231
    v_lshlrev_b32 v230, 16, v31
    v_and_b32 v231, 0xffff0000, v31
    v_fma_f32 v230, v230, v229, -v228
    v_fma_f32 v231, v231, v229, -v228
    v_cvt_pk_bf16_f32 v39, v230, v231
    s_waitcnt vmcnt(17)
    v_perm_b32 v160, v68, v64, s40
    v_perm_b32 v164, v68, v64, s41
    v_perm_b32 v168, v69, v65, s40
    v_perm_b32 v172, v69, v65, s41
    v_perm_b32 v176, v70, v66, s40
    v_perm_b32 v180, v70, v66, s41
    v_perm_b32 v184, v71, v67, s40
    v_perm_b32 v188, v71, v67, s41
    s_waitcnt vmcnt(15)
    v_perm_b32 v161, v76, v72, s40
    v_perm_b32 v165, v76, v72, s41
    v_perm_b32 v169, v77, v73, s40
    v_perm_b32 v173, v77, v73, s41
    v_perm_b32 v177, v78, v74, s40
    v_perm_b32 v181, v78, v74, s41
    v_perm_b32 v185, v79, v75, s40
    v_perm_b32 v189, v79, v75, s41
    s_waitcnt vmcnt(13)
    v_perm_b32 v162, v84, v80, s40
    v_perm_b32 v166, v84, v80, s41
    v_perm_b32 v170, v85, v81, s40
    v_perm_b32 v174, v85, v81, s41
    v_perm_b32 v178, v86, v82, s40
    v_perm_b32 v182, v86, v82, s41
    v_perm_b32 v186, v87, v83, s40
    v_perm_b32 v190, v87, v83, s41
    s_waitcnt vmcnt(11)
    v_perm_b32 v163, v92, v88, s40
    v_perm_b32 v167, v92, v88, s41
    v_perm_b32 v171, v93, v89, s40
    v_perm_b32 v175, v93, v89, s41
    v_perm_b32 v179, v94, v90, s40
    v_perm_b32 v183, v94, v90, s41
    v_perm_b32 v187, v95, v91, s40
    v_perm_b32 v191, v95, v91, s41
    s_waitcnt vmcnt(9)
    v_perm_b32 v192, v100, v96, s40
    v_mfma_f32_16x16x32_bf16 v[128:131], v[160:163], v[32:35], 0
    v_perm_b32 v196, v100, v96, s41
    v_mfma_f32_16x16x32_bf16 v[132:135], v[164:167], v[32:35], 0
    v_perm_b32 v200, v101, v97, s40
    v_mfma_f32_16x16x32_bf16 v[136:139], v[168:171], v[32:35], 0
    v_perm_b32 v204, v101, v97, s41
    v_mfma_f32_16x16x32_bf16 v[140:143], v[172:175], v[32:35], 0
    v_perm_b32 v208, v102, v98, s40
    v_mfma_f32_16x16x32_bf16 v[144:147], v[176:179], v[32:35], 0
    v_perm_b32 v212, v102, v98, s41
    v_mfma_f32_16x16x32_bf16 v[148:151], v[180:183], v[32:35], 0
    v_perm_b32 v216, v103, v99, s40
    v_mfma_f32_16x16x32_bf16 v[152:155], v[184:187], v[32:35], 0
    v_perm_b32 v220, v103, v99, s41
    v_mfma_f32_16x16x32_bf16 v[156:159], v[188:191], v[32:35], 0
    s_waitcnt vmcnt(7)
    v_perm_b32 v193, v108, v104, s40
    v_perm_b32 v197, v108, v104, s41
    v_perm_b32 v201, v109, v105, s40
    v_perm_b32 v205, v109, v105, s41
    v_perm_b32 v209, v110, v106, s40
    v_perm_b32 v213, v110, v106, s41
    v_perm_b32 v217, v111, v107, s40
    v_perm_b32 v221, v111, v107, s41
    s_waitcnt vmcnt(5)
    v_perm_b32 v194, v116, v112, s40
    v_perm_b32 v198, v116, v112, s41
    v_perm_b32 v202, v117, v113, s40
    v_perm_b32 v206, v117, v113, s41
    v_perm_b32 v210, v118, v114, s40
    v_perm_b32 v214, v118, v114, s41
    v_perm_b32 v218, v119, v115, s40
    v_perm_b32 v222, v119, v115, s41
    s_waitcnt vmcnt(3)
    v_perm_b32 v195, v124, v120, s40
    v_perm_b32 v199, v124, v120, s41
    v_perm_b32 v203, v125, v121, s40
    v_mfma_f32_16x16x32_bf16 v[128:131], v[192:195], v[36:39], v[128:131]
    v_perm_b32 v207, v125, v121, s41
    v_mfma_f32_16x16x32_bf16 v[132:135], v[196:199], v[36:39], v[132:135]
    v_perm_b32 v211, v126, v122, s40
    v_mfma_f32_16x16x32_bf16 v[136:139], v[200:203], v[36:39], v[136:139]
    v_perm_b32 v215, v126, v122, s41
    v_mfma_f32_16x16x32_bf16 v[140:143], v[204:207], v[36:39], v[140:143]
    v_perm_b32 v219, v127, v123, s40
    v_mfma_f32_16x16x32_bf16 v[144:147], v[208:211], v[36:39], v[144:147]
    v_perm_b32 v223, v127, v123, s41
    v_mfma_f32_16x16x32_bf16 v[148:151], v[212:215], v[36:39], v[148:151]
    v_mfma_f32_16x16x32_bf16 v[152:155], v[216:219], v[36:39], v[152:155]
    v_mfma_f32_16x16x32_bf16 v[156:159], v[220:223], v[36:39], v[156:159]
    v_permlane32_swap_b32 v128, v130
    v_permlane32_swap_b32 v129, v131
    v_permlane32_swap_b32 v132, v134
    v_permlane32_swap_b32 v133, v135
    v_permlane32_swap_b32 v136, v138
    v_permlane32_swap_b32 v137, v139
    v_permlane32_swap_b32 v140, v142
    v_permlane32_swap_b32 v141, v143
    v_add_f32_dpp v128, v130, v128 row_ror:8 row_mask:0xf bank_mask:0x3
    v_add_f32_dpp v132, v134, v132 row_ror:8 row_mask:0xf bank_mask:0x3
    v_add_f32_dpp v136, v138, v136 row_ror:8 row_mask:0xf bank_mask:0x3
    v_add_f32_dpp v140, v142, v140 row_ror:8 row_mask:0xf bank_mask:0x3
    v_add_f32_dpp v128, v129, v131 row_ror:8 row_mask:0xf bank_mask:0xc
    v_add_f32_dpp v132, v133, v135 row_ror:8 row_mask:0xf bank_mask:0xc
    v_add_f32_dpp v136, v137, v139 row_ror:8 row_mask:0xf bank_mask:0xc
    v_add_f32_dpp v140, v141, v143 row_ror:8 row_mask:0xf bank_mask:0xc
    v_cvt_pk_bf16_f32 v8, v128, v132
    v_cvt_pk_bf16_f32 v9, v136, v140
    v_permlane32_swap_b32 v144, v146
    v_permlane32_swap_b32 v145, v147
    v_permlane32_swap_b32 v148, v150
    v_permlane32_swap_b32 v149, v151
    v_permlane32_swap_b32 v152, v154
    v_permlane32_swap_b32 v153, v155
    v_permlane32_swap_b32 v156, v158
    v_permlane32_swap_b32 v157, v159
    v_add_f32_dpp v144, v146, v144 row_ror:8 row_mask:0xf bank_mask:0x3
    v_add_f32_dpp v148, v150, v148 row_ror:8 row_mask:0xf bank_mask:0x3
    v_add_f32_dpp v152, v154, v152 row_ror:8 row_mask:0xf bank_mask:0x3
    v_add_f32_dpp v156, v158, v156 row_ror:8 row_mask:0xf bank_mask:0x3
    v_add_f32_dpp v144, v145, v147 row_ror:8 row_mask:0xf bank_mask:0xc
    v_add_f32_dpp v148, v149, v151 row_ror:8 row_mask:0xf bank_mask:0xc
    v_add_f32_dpp v152, v153, v155 row_ror:8 row_mask:0xf bank_mask:0xc
    v_add_f32_dpp v156, v157, v159 row_ror:8 row_mask:0xf bank_mask:0xc
    v_cvt_pk_bf16_f32 v12, v144, v148
    v_cvt_pk_bf16_f32 v13, v152, v156
    s_waitcnt vmcnt(0)
    buffer_store_dwordx4 v[8:11], v6, s[52:55], s5 offen
    buffer_store_dwordx4 v[12:15], v6, s[52:55], s5 offen offset:128
    s_setprio 0
    s_add_u32 s5, s5, 524288
    v_mov_b32 v232, 145536
    s_mov_b32 s94, 0
L_qw:
    ds_read_b128 v[24:27], v232
    ds_read_b32 v28, v232 offset:64
    s_add_u32 s94, s94, 1
    s_waitcnt lgkmcnt(0)
    v_and_b32 v24, v24, v25
    v_and_b32 v26, v26, v27
    v_and_b32 v24, v24, v26
    v_lshl_or_b32 v24, v28, 2, v24
    s_cmp_gt_u32 s94, 60000
    v_readfirstlane_b32 s6, v24
    s_cbranch_scc1 L_qg
    s_cmp_eq_u32 s6, 0
    s_cbranch_scc1 L_qw
    s_cmp_eq_u32 s6, 3
    s_cbranch_scc1 L_qsk
L_qg:
    buffer_store_dwordx4 v[8:11], v6, s[52:55], s5 offen sc1
    buffer_store_dwordx4 v[12:15], v6, s[52:55], s5 offen offset:128 sc1
L_qsk:
    s_barrier
    ds_read_b128 v[24:27], v232
    s_waitcnt lgkmcnt(0)
    v_and_b32 v24, v24, v25
    v_and_b32 v26, v26, v27
    v_and_b32 v24, v24, v26
    s_nop 0
    v_readfirstlane_b32 s6, v24
    s_nop 0
    s_cmp_eq_u32 s6, 3
    s_cbranch_scc1 L_qlc
    buffer_store_dwordx4 v[20:23], v17, s[52:55], s8 offen sc1
    s_mov_b64 exec, 15
    buffer_store_dword v20, v7, s[52:55], s9 offen sc1
    s_mov_b64 exec, -1
    buffer_store_dwordx4 v[20:23], v16, s[52:55], s10 offen sc1
    s_waitcnt vmcnt(0)
L_qlc:
    s_barrier
    s_branch L_exit
L_probe:
    s_waitcnt lgkmcnt(0)
    s_load_dwordx2 s[38:39], s[52:53], 0
    s_load_dwordx2 s[56:57], s[0:1], 88
    s_movk_i32 s58, 256
    s_mov_b32 s59, 0x00020000
    s_mul_i32 s35, s30, 7
    s_lshr_b32 s6, s31, 1
    s_add_u32 s35, s35, s6
    s_sub_u32 s35, s35, 8
    s_and_b32 s6, s31, 1
    s_add_u32 s6, s6, 2
    s_cmp_lt_u32 s31, 30
    s_cselect_b32 s36, s6, 0
    s_cmp_lt_u32 s31, 16
    s_cselect_b32 s36, 1, s36
    s_lshr_b32 s32, s31, 3
    s_lshl_b32 s6, s32, 1
    s_cmp_ge_u32 s30, 4
    s_cselect_b32 s36, 1, s36
    s_cselect_b32 s32, s32, s6
    s_lshl_b32 s33, s30, 2
    s_add_u32 s33, s33, s32
    v_and_b32 v9, 7, v0
    v_lshlrev_b32 v233, 4, v9
    v_mov_b32 v20, -1
    v_mov_b32 v21, -1
    v_mov_b32 v22, -1
    v_mov_b32 v23, -1
    v_lshrrev_b32 v8, 3, v0
    s_lshl_b32 s4, s30, 5
    s_add_u32 s4, s4, s31
    s_lshl_b32 s4, s4, 3
    s_add_u32 s4, s4, 4096
    s_waitcnt lgkmcnt(0)
    s_getreg_b32 s91, hwreg(HW_REG_XCC_ID)
    s_add_u32 s38, s38, 1
    s_and_b32 s39, s39, 0x0fffffff
    s_lshl_b32 s91, s91, 28
    s_or_b32 s39, s39, s91
    v_mov_b32 v10, s38
    v_mov_b32 v11, s39
    s_cmp_ge_u32 s2, 4
    s_cbranch_scc1 L_psel
    s_lshl_b32 s8, s2, 7
    s_add_u32 s8, s8, 262144
    s_add_u32 s8, s52, s8
    s_addc_u32 s9, s53, 0
    s_load_dword s10, s[8:9], 0 glc
    s_load_dword s11, s[8:9], 0x2000 glc
    s_mov_b32 s12, -1
    s_mov_b32 s13, -1
    s_mov_b32 s14, 0
    s_waitcnt lgkmcnt(0)
L_prb:
    s_memtime s[16:17]
    s_waitcnt lgkmcnt(0)
    s_load_dword s10, s[8:9], 0 glc
    s_waitcnt lgkmcnt(0)
    s_memtime s[18:19]
    s_waitcnt lgkmcnt(0)
    s_sub_u32 s16, s18, s16
    s_min_u32 s12, s12, s16
    s_cmp_lt_u32 s12, 620
    s_cbranch_scc1 L_prd
    s_load_dword s10, s[8:9], 0x2000 glc
    s_waitcnt lgkmcnt(0)
    s_memtime s[20:21]
    s_waitcnt lgkmcnt(0)
    s_sub_u32 s18, s20, s18
    s_min_u32 s13, s13, s18
    s_cmp_lt_u32 s13, 620
    s_cbranch_scc1 L_prd
    s_add_u32 s14, s14, 1
    s_cmp_lt_u32 s14, 3
    s_cbranch_scc1 L_prb
L_prd:
    s_cmp_gt_u32 s12, s13
    s_cselect_b32 s14, 3, 2
    v_mov_b32 v12, s14
    v_mov_b32 v13, 0
    s_mov_b64 exec, 1
    buffer_atomic_cmpswap v[12:13], off, s[56:59], 0 offset:128 sc0 sc1
    s_mov_b64 exec, -1
    s_waitcnt vmcnt(0)
    v_readfirstlane_b32 s99, v12
    s_nop 0
    s_cmp_eq_u32 s99, 0
    s_cselect_b32 s99, s14, s99
    s_branch L_pgo
L_psel:
    s_and_b32 s5, s36, 1
    s_cbranch_scc0 L_clrd
    s_mov_b32 s94, 0
L_pl:
    buffer_load_dword v12, off, s[56:59], 0 offset:128 sc1
    s_add_u32 s94, s94, 1
    s_waitcnt vmcnt(0)
    v_readfirstlane_b32 s99, v12
    s_cmp_gt_u32 s94, 60000
    s_cbranch_scc1 L_pgo
    s_cmp_eq_u32 s99, 0
    s_cbranch_scc1 L_pl
L_pgo:
    s_and_b32 s99, s99, 1
    s_lshl_b32 s99, s99, 13
    v_mov_b32 v12, 145608
    v_mov_b32 v13, s99
    ds_write_b32 v12, v13
    s_cmp_eq_u32 s36, 3
    s_cbranch_scc1 L_clrf
    v_lshl_add_u32 v9, v8, 16, v233
    s_lshl_b32 s5, s33, 7
    s_and_b32 s6, s31, 6
    s_and_b32 s7, s31, 7
    s_add_u32 s6, s6, s7
    s_lshl_b32 s6, s6, 12
    s_add_u32 s5, s5, s6
    s_add_u32 s5, s5, 524288
    s_add_u32 s5, s5, s99
    buffer_store_dwordx4 v[20:23], v9, s[52:55], s5 offen sc1
    s_cmp_ge_u32 s30, 4
    s_cbranch_scc1 L_clrd
    buffer_store_dwordx4 v[20:23], v9, s[52:55], s5 offen offset:128 sc1
    s_branch L_clrd
L_clrf:
    v_and_b32 v9, 6, v8
    v_add_u32 v9, v9, v8
    v_lshl_add_u32 v9, v9, 12, v233
    s_lshl_b32 s5, s35, 7
    s_add_u32 s5, s5, 1048576
    s_add_u32 s5, s5, s99
    s_add_u32 s7, s5, 524288
L_clp:
    buffer_store_dwordx4 v[20:23], v9, s[52:55], s5 offen sc1
    s_add_u32 s5, s5, 65536
    s_cmp_lt_u32 s5, s7
    s_cbranch_scc1 L_clp
L_clrd:
    v_mov_b32 v12, 145536
    s_waitcnt lgkmcnt(0)
    s_barrier
    ds_read_b128 v[24:27], v12
    s_mov_b64 exec, 1
    s_waitcnt vmcnt(0) lgkmcnt(0)
    v_and_b32 v24, v24, v25
    v_and_b32 v26, v26, v27
    v_and_b32 v24, v24, v26
    s_nop 0
    v_readfirstlane_b32 s6, v24
    s_nop 0
    s_cmp_eq_u32 s6, 3
    s_cbranch_scc0 L_tlate
    buffer_store_dwordx2 v[10:11], v3, s[52:55], s4 offen sc1
    s_barrier
    s_branch L_exit
L_tlate:
    s_barrier
    buffer_store_dwordx2 v[10:11], v3, s[52:55], s4 offen sc1
L_exit:
L_end:
    s_endpgm
L_codeend:
.section .rodata,"a"
.p2align 6
.amdhsa_kernel sequential_preLN__sliding_block_cached__dense_activation_gelu__decode_kernel
  .amdhsa_next_free_vgpr 256
  .amdhsa_next_free_sgpr 102
  .amdhsa_accum_offset 256
  .amdhsa_group_segment_fixed_size 0
  .amdhsa_kernarg_size 104
  .amdhsa_user_sgpr_count 2
  .amdhsa_user_sgpr_kernarg_segment_ptr 1
  .amdhsa_system_sgpr_workgroup_id_x 1
  .amdhsa_float_denorm_mode_32 3
.end_amdhsa_kernel
```
